```python
import torch

def _softmax(x, axis=-1):
    return torch.softmax(x, dim=axis)
def _gelu(x):
    return torch.nn.functional.gelu(x, approximate="tanh")
def _silu(x):
    return torch.nn.functional.silu(x)
def _sigmoid(x):
    return torch.sigmoid(x)
def _layernorm(x, axis=-1, eps=1e-5):
    m = x.mean(dim=axis, keepdim=True)
    v = x.var(dim=axis, keepdim=True, unbiased=False)
    return (x - m) / torch.sqrt(v + eps)
def _scatter_add(tgt, idx, src, axis=0):
    return tgt.clone().index_add_(axis, idx, src)
def _segment_sum(src, seg, n):
    out = torch.zeros((n,) + src.shape[1:], dtype=src.dtype)
    return out.index_add_(0, seg, src)
def _pad(x, pw):
    flat = tuple(v for pair in reversed(pw) for v in pair)
    return torch.nn.functional.pad(x, flat)

kernel_name = 'standalone__se_block__vision'

def setup_inputs():

    _w = (lambda a: (lambda t: t.to(torch.bfloat16) if t.is_floating_point() else t)(torch.as_tensor(a)))
    H = W = 512
    C = 192; r = max(C // 16, 4)
    return {
        "x": _w((lambda *s: torch.randn(*s, dtype=torch.bfloat16) * 3.2)(1, H, W, C)),
        "w_down": _w((lambda *s: torch.randn(*s, dtype=torch.bfloat16) * 3.2)(C, r)),
        "w_up": _w((lambda *s: torch.randn(*s, dtype=torch.bfloat16) * 3.2)(r, C)),
    }

def reference(x, w_down, w_up):
    s = x.mean(axis=(1, 2))
    s = _sigmoid(_silu(s @ w_down) @ w_up)
    return x * s[:, None, None, :]
```

```asm
; @launch grid=(256,1,1) block=(512,1,1) lds=22528
.amdgcn_target "amdgcn-amd-amdhsa--gfx950"
.text
.globl standalone__se_block__vision_kernel
.p2align 8
.type standalone__se_block__vision_kernel,@function
standalone__se_block__vision_kernel:
    s_load_dwordx2 s[16:17], s[0:1], 0
    s_cmpk_ge_u32 s2, 256
    s_cbranch_scc1 L_end
    v_lshrrev_b32 v2, 6, v0
    v_and_b32 v5, 12, v0
    v_readfirstlane_b32 s36, v2
    v_and_b32 v6, 32, v0
    v_lshl_add_u32 v5, v5, 1, v6
    v_and_b32 v6, 3, v0
    v_and_b32 v7, 16, v0
    v_lshl_add_u32 v6, v6, 2, v7
    v_lshlrev_b32 v6, 2, v6
    v_mad_u32_u24 v1, v5, 48, v6
    s_lshr_b32 s56, s2, 1
    s_lshl3_add_u32 s56, s56, s36
    s_and_b32 s45, s2, 1
    s_lshl1_add_u32 s56, s56, s45
    s_mulk_i32 s56, 3072
    s_bfm_b32 s18, 2, 25
    s_lshl_b32 s19, 1, 17
    s_and_b32 s46, s2, 0x39
    s_cbranch_scc0 L_special
L_w:
    s_waitcnt lgkmcnt(0)
L_loads:
    buffer_load_dwordx4 v[64:67], v1, s[16:19], s56 offen offset:0 nt
    buffer_load_dwordx4 v[68:71], v1, s[16:19], s56 offen offset:128 nt
    buffer_load_dwordx4 v[72:75], v1, s[16:19], s56 offen offset:256 nt
    s_mov_b32 s94, 0
L_loads2:
    s_load_dwordx2 s[24:25], s[0:1], 8
    s_load_dwordx2 s[28:29], s[0:1], 16
    s_load_dwordx2 s[20:21], s[0:1], 24
    s_load_dwordx2 s[32:33], s[0:1], 32
    s_load_dwordx2 s[40:41], s[0:1], 40
    v_and_b32 v3, 63, v0
    v_lshlrev_b32 v4, 4, v0
    s_movk_i32 s26, 4608
    s_mov_b32 s27, s19
    v_add_u32 v7, -1024, v4
    s_movk_i32 s30, 4608
    s_mov_b32 s31, s19
    v_min_u32 v7, 0x2000, v7
    s_waitcnt lgkmcnt(0)
    buffer_load_dwordx4 v[56:59], v7, s[24:27], 0 offen
    buffer_load_dwordx4 v[60:63], v7, s[28:31], 0 offen
    s_add_u32 s37, s56, 6291456
    buffer_load_dwordx4 v[76:79], v1, s[16:19], s37 offen offset:0 nt
    buffer_load_dwordx4 v[80:83], v1, s[16:19], s37 offen offset:128 nt
    buffer_load_dwordx4 v[84:87], v1, s[16:19], s37 offen offset:256 nt
    s_add_u32 s37, s37, 6291456
    buffer_load_dwordx4 v[88:91], v1, s[16:19], s37 offen offset:0 nt
    buffer_load_dwordx4 v[92:95], v1, s[16:19], s37 offen offset:128 nt
    buffer_load_dwordx4 v[96:99], v1, s[16:19], s37 offen offset:256 nt
    s_add_u32 s37, s37, 6291456
    buffer_load_dwordx4 v[100:103], v1, s[16:19], s37 offen offset:0 nt
    buffer_load_dwordx4 v[104:107], v1, s[16:19], s37 offen offset:128 nt
    buffer_load_dwordx4 v[108:111], v1, s[16:19], s37 offen offset:256 nt
    s_add_u32 s37, s37, 6291456
    buffer_load_dwordx4 v[112:115], v1, s[16:19], s37 offen offset:0 nt
    buffer_load_dwordx4 v[116:119], v1, s[16:19], s37 offen offset:128 nt
    buffer_load_dwordx4 v[120:123], v1, s[16:19], s37 offen offset:256 nt
    s_add_u32 s37, s37, 6291456
    buffer_load_dwordx4 v[124:127], v1, s[16:19], s37 offen offset:0 nt
    buffer_load_dwordx4 v[128:131], v1, s[16:19], s37 offen offset:128 nt
    buffer_load_dwordx4 v[132:135], v1, s[16:19], s37 offen offset:256 nt
    s_add_u32 s37, s37, 6291456
    buffer_load_dwordx4 v[136:139], v1, s[16:19], s37 offen offset:0 nt
    buffer_load_dwordx4 v[140:143], v1, s[16:19], s37 offen offset:128 nt
    buffer_load_dwordx4 v[144:147], v1, s[16:19], s37 offen offset:256 nt
    s_add_u32 s37, s37, 6291456
    buffer_load_dwordx4 v[148:151], v1, s[16:19], s37 offen offset:0 nt
    buffer_load_dwordx4 v[152:155], v1, s[16:19], s37 offen offset:128 nt
    buffer_load_dwordx4 v[156:159], v1, s[16:19], s37 offen offset:256 nt
    s_add_u32 s37, s37, 6291456
    buffer_load_dwordx4 v[160:163], v1, s[16:19], s37 offen offset:0 nt
    buffer_load_dwordx4 v[164:167], v1, s[16:19], s37 offen offset:128 nt
    buffer_load_dwordx4 v[168:171], v1, s[16:19], s37 offen offset:256 nt
    s_add_u32 s37, s37, 6291456
    buffer_load_dwordx4 v[172:175], v1, s[16:19], s37 offen offset:0 nt
    s_getpc_b64 s[4:5]
L_pc:
    s_lshr_b32 s45, s2, 3
    s_lshl3_add_u32 s6, s45, s36
    s_lshl_b32 s6, s6, 6
    s_min_u32 s6, s6, L_restart-L_pc
    s_load_dword s6, s[4:5], s6
    v_lshlrev_b32 v9, 4, v3
    s_mov_b32 s22, 100663296
    s_mov_b32 s23, 0x20000
    s_mov_b32 s34, 256
    s_mov_b32 s35, 0x20000
    s_mov_b32 s42, 402653184
    s_mov_b32 s43, 0x20000
    s_getreg_b32 s59, hwreg(HW_REG_XCC_ID)
    s_bfe_u32 s57, s59, 0x10002
    s_cmp_eq_u32 s94, 1
    s_cselect_b32 s92, s2, s59
    s_sub_u32 s92, s92, s2
    s_and_b32 s92, s92, 7
    s_lshl_b32 s93, s94, 14
    s_add_u32 s93, s93, 1048576
    s_and_b32 s58, s59, 3
    s_lshl2_add_u32 s58, s45, s58
    s_mul_i32 s3, s58, 6
    s_add_u32 s3, s3, 3
    s_lshr_b32 s3, s3, 8
    s_add_u32 s100, s56, 81788928
    s_add_u32 s101, s100, 0xc00
    s_bitcmp1_b32 s2, 0
    s_cselect_b32 s100, 0x70000000, s100
    s_cselect_b32 s101, 0x70000000, s101
    s_mov_b32 s39, 0xffff0000
    s_lshl_b32 s44, s2, 6
    s_add_u32 s44, s44, s93
    v_and_b32 v8, 60, v3
    v_and_b32 v5, 16, v3
    v_mul_u32_u24 v5, 48, v5
    v_bfe_u32 v13, v3, 2, 2
    v_mul_u32_u24 v6, 192, v13
    v_add_u32 v5, v5, v6
    v_and_b32 v11, 3, v3
    v_lshl_add_u32 v5, v11, 1, v5
    s_mul_i32 s46, s36, 11
    s_lshr_b32 s46, s46, 5
    s_mul_i32 s47, s46, 3
    s_sub_u32 s47, s36, s47
    s_mul_i32 s46, s46, 1536
    s_lshl3_add_u32 s46, s47, s46
    v_add_u32 v6, s46, v5
    v_and_b32 v10, 16, v3
    v_lshlrev_b32 v10, 3, v10
    v_lshl_add_u32 v10, v11, 5, v10
    v_lshrrev_b32 v14, 4, v3
    v_mad_u32_u24 v12, v14, 3, v13
    v_mul_u32_u24 v12, 144, v12
    v_lshl_add_u32 v12, v11, 5, v12
    v_cmp_eq_u32 s[10:11], 3, v13
    v_mul_u32_u24 v11, 144, v11
    v_lshl_add_u32 v11, v14, 2, v11
    s_lshl_b32 s46, s36, 4
    v_add_u32 v11, s46, v11
    v_mov_b32 v13, 0
    v_mov_b32 v2, s92
    s_waitcnt vmcnt(25)
    s_cmp_eq_u32 s94, 1
    s_cbranch_scc1 L_bread
    ds_write_b32 v13, v13 offset:22016
    v_cmp_gt_u32 vcc, 4608, v7
    s_and_saveexec_b64 s[48:49], vcc
    ds_write_b128 v7, v[56:59] offset:0
    ds_write_b128 v7, v[60:63] offset:4608
    s_mov_b64 exec, s[48:49]
    s_waitcnt lgkmcnt(0)
    s_barrier
    s_lshl3_add_u32 s46, s2, s36
    s_cmpk_eq_u32 s46, 519
    s_cbranch_scc1 L_flag
L_flag_back:
    ds_read_u16 v16, v6 offset:0
    ds_read_u16 v17, v6 offset:24
    ds_read_u16 v18, v6 offset:48
    ds_read_u16 v19, v6 offset:72
    ds_read_u16 v20, v6 offset:96
    ds_read_u16 v21, v6 offset:120
    ds_read_u16 v22, v6 offset:144
    ds_read_u16 v23, v6 offset:168
    s_waitcnt lgkmcnt(0)
    v_lshl_or_b32 v24, v17, 16, v16
    v_lshl_or_b32 v25, v19, 16, v18
    v_lshl_or_b32 v26, v21, 16, v20
    v_lshl_or_b32 v27, v23, 16, v22
    ds_write_b128 v4, v[24:27] offset:9216
    s_cmp_lg_u32 s36, 7
    s_cbranch_scc1 L_nob8
    ds_read_u16 v16, v5 offset:3088
    ds_read_u16 v17, v5 offset:3112
    ds_read_u16 v18, v5 offset:3136
    ds_read_u16 v19, v5 offset:3160
    ds_read_u16 v20, v5 offset:3184
    ds_read_u16 v21, v5 offset:3208
    ds_read_u16 v22, v5 offset:3232
    ds_read_u16 v23, v5 offset:3256
    s_waitcnt lgkmcnt(0)
    v_lshl_or_b32 v24, v17, 16, v16
    v_lshl_or_b32 v25, v19, 16, v18
    v_lshl_or_b32 v26, v21, 16, v20
    v_lshl_or_b32 v27, v23, 16, v22
    ds_write_b128 v9, v[24:27] offset:17408
L_nob8:
    s_waitcnt lgkmcnt(0)
    s_barrier
L_bread:
    ds_read_b128 v[16:19], v9 offset:9216
    ds_read_b128 v[20:23], v9 offset:10240
    ds_read_b128 v[24:27], v9 offset:11264
    ds_read_b128 v[28:31], v9 offset:12288
    ds_read_b128 v[32:35], v9 offset:13312
    ds_read_b128 v[36:39], v9 offset:14336
    ds_read_b128 v[40:43], v9 offset:15360
    ds_read_b128 v[44:47], v9 offset:16384
    ds_read_b128 v[48:51], v9 offset:17408
    s_waitcnt lgkmcnt(0)
    s_waitcnt vmcnt(29)
    v_mfma_f32_16x16x32_bf16 v[52:55], v[64:67], v[16:19], 0
    v_mfma_f32_16x16x32_bf16 v[56:59], v[64:67], v[20:23], 0
    v_mfma_f32_16x16x32_bf16 v[60:63], v[64:67], v[24:27], 0
    buffer_load_dwordx4 v[176:179], v1, s[16:19], s37 offen offset:128 nt
    s_waitcnt vmcnt(29)
    v_mfma_f32_16x16x32_bf16 v[52:55], v[68:71], v[28:31], v[52:55]
    v_mfma_f32_16x16x32_bf16 v[56:59], v[68:71], v[32:35], v[56:59]
    v_mfma_f32_16x16x32_bf16 v[60:63], v[68:71], v[36:39], v[60:63]
    buffer_load_dwordx4 v[180:183], v1, s[16:19], s37 offen offset:256 nt
    s_waitcnt vmcnt(29)
    v_mfma_f32_16x16x32_bf16 v[52:55], v[72:75], v[40:43], v[52:55]
    v_mfma_f32_16x16x32_bf16 v[56:59], v[72:75], v[44:47], v[56:59]
    v_mfma_f32_16x16x32_bf16 v[60:63], v[72:75], v[48:51], v[60:63]
    s_add_u32 s37, s37, 6291456
    buffer_load_dwordx4 v[184:187], v1, s[16:19], s37 offen offset:0 nt
    s_load_dwordx16 s[76:91], s[32:33], 0
    s_waitcnt vmcnt(27)
    v_mfma_f32_16x16x32_bf16 v[52:55], v[76:79], v[16:19], v[52:55]
    v_mfma_f32_16x16x32_bf16 v[56:59], v[76:79], v[20:23], v[56:59]
    v_mfma_f32_16x16x32_bf16 v[60:63], v[76:79], v[24:27], v[60:63]
    buffer_load_dwordx4 v[188:191], v1, s[16:19], s37 offen offset:128 nt
    s_waitcnt vmcnt(27)
    v_mfma_f32_16x16x32_bf16 v[52:55], v[80:83], v[28:31], v[52:55]
    v_mfma_f32_16x16x32_bf16 v[56:59], v[80:83], v[32:35], v[56:59]
    v_mfma_f32_16x16x32_bf16 v[60:63], v[80:83], v[36:39], v[60:63]
    s_mov_b32 s54, s56
    s_mov_b32 s55, s56
    s_waitcnt lgkmcnt(0)
    s_cmp_eq_u32 s94, 1
    s_cbranch_scc1 L_votes_static
    s_and_b32 s45, s76, s77
    s_and_b32 s45, s45, s78
    s_and_b32 s45, s45, s79
    s_and_b32 s45, s45, s80
    s_and_b32 s45, s45, s81
    s_and_b32 s45, s45, s82
    s_and_b32 s45, s45, s83
    s_and_b32 s45, s45, s84
    s_and_b32 s45, s45, s85
    s_and_b32 s45, s45, s86
    s_and_b32 s45, s45, s87
    s_bitcmp1_b32 s45, 1
    s_cbranch_scc0 L_votes_slow
L_votes_ok:
    s_add_u32 s46, s20, 1536
    s_lshr_b32 s46, s46, 10
    s_lshr_b32 s47, s36, 2
    s_lshl1_add_u32 s47, s36, s47
    s_and_b32 s47, s47, 7
    s_sub_u32 s46, s47, s46
    s_mul_i32 s46, s46, 11
    s_and_b32 s54, s46, 15
    s_xor_b32 s55, s54, 8
    s_lshl4_add_u32 s54, s58, s54
    s_mulk_i32 s54, 3072
    s_lshl4_add_u32 s55, s58, s55
    s_mulk_i32 s55, 3072
L_votes_static:
    s_cmp_eq_u32 s57, 1
    s_cselect_b32 s98, s55, s54
    s_cselect_b32 s99, s54, s55
    s_mov_b32 s96, 0xaaaaaaaa
    s_mov_b32 s97, 0xaaaa
    s_add_u32 s45, s76, s77
    s_add_u32 s45, s45, s78
    s_cmp_gt_u32 s45, 7
    s_cselect_b32 s46, 0xe, 0
    s_xor_b32 s97, s97, s46
    s_add_u32 s45, s79, s80
    s_add_u32 s45, s45, s81
    s_cmp_gt_u32 s45, 7
    s_cselect_b32 s46, 0x70, 0
    s_xor_b32 s97, s97, s46
    s_add_u32 s45, s82, s83
    s_add_u32 s45, s45, s84
    s_cmp_gt_u32 s45, 7
    s_cselect_b32 s46, 0x1c00, 0
    s_xor_b32 s97, s97, s46
    s_add_u32 s45, s85, s86
    s_add_u32 s45, s45, s87
    s_cmp_gt_u32 s45, 7
    s_cselect_b32 s46, 0xe000, 0
    s_xor_b32 s97, s97, s46
    s_lshr_b64 s[96:97], s[96:97], s3
    buffer_load_dwordx4 v[192:195], v1, s[16:19], s37 offen offset:256 nt
    s_waitcnt vmcnt(27)
    v_mfma_f32_16x16x32_bf16 v[52:55], v[84:87], v[40:43], v[52:55]
    v_mfma_f32_16x16x32_bf16 v[56:59], v[84:87], v[44:47], v[56:59]
    v_mfma_f32_16x16x32_bf16 v[60:63], v[84:87], v[48:51], v[60:63]
    s_bitcmp1_b64 s[96:97], 33
    s_cselect_b32 s95, s99, s98
    s_add_u32 s95, s95, 69206016
    buffer_load_dwordx4 v[196:199], v1, s[16:19], s95 offen offset:0 nt
    s_waitcnt vmcnt(27)
    v_mfma_f32_16x16x32_bf16 v[52:55], v[88:91], v[16:19], v[52:55]
    v_mfma_f32_16x16x32_bf16 v[56:59], v[88:91], v[20:23], v[56:59]
    v_mfma_f32_16x16x32_bf16 v[60:63], v[88:91], v[24:27], v[60:63]
    buffer_load_dwordx4 v[200:203], v1, s[16:19], s95 offen offset:128 nt
    s_waitcnt vmcnt(27)
    v_mfma_f32_16x16x32_bf16 v[52:55], v[92:95], v[28:31], v[52:55]
    v_mfma_f32_16x16x32_bf16 v[56:59], v[92:95], v[32:35], v[56:59]
    v_mfma_f32_16x16x32_bf16 v[60:63], v[92:95], v[36:39], v[60:63]
    buffer_load_dwordx4 v[204:207], v1, s[16:19], s95 offen offset:256 nt
    s_waitcnt vmcnt(27)
    v_mfma_f32_16x16x32_bf16 v[52:55], v[96:99], v[40:43], v[52:55]
    v_mfma_f32_16x16x32_bf16 v[56:59], v[96:99], v[44:47], v[56:59]
    v_mfma_f32_16x16x32_bf16 v[60:63], v[96:99], v[48:51], v[60:63]
    s_bitcmp1_b64 s[96:97], 36
    s_cselect_b32 s95, s99, s98
    s_add_u32 s95, s95, 75497472
    buffer_load_dwordx4 v[208:211], v1, s[16:19], s95 offen offset:0 nt
    s_waitcnt vmcnt(27)
    v_mfma_f32_16x16x32_bf16 v[52:55], v[100:103], v[16:19], v[52:55]
    v_mfma_f32_16x16x32_bf16 v[56:59], v[100:103], v[20:23], v[56:59]
    v_mfma_f32_16x16x32_bf16 v[60:63], v[100:103], v[24:27], v[60:63]
    buffer_load_dwordx4 v[212:215], v1, s[16:19], s95 offen offset:128 nt
    s_waitcnt vmcnt(27)
    v_mfma_f32_16x16x32_bf16 v[52:55], v[104:107], v[28:31], v[52:55]
    v_mfma_f32_16x16x32_bf16 v[56:59], v[104:107], v[32:35], v[56:59]
    v_mfma_f32_16x16x32_bf16 v[60:63], v[104:107], v[36:39], v[60:63]
    buffer_load_dwordx4 v[216:219], v1, s[16:19], s95 offen offset:256 nt
    s_waitcnt vmcnt(27)
    v_mfma_f32_16x16x32_bf16 v[52:55], v[108:111], v[40:43], v[52:55]
    v_mfma_f32_16x16x32_bf16 v[56:59], v[108:111], v[44:47], v[56:59]
    v_mfma_f32_16x16x32_bf16 v[60:63], v[108:111], v[48:51], v[60:63]
    s_add_u32 s37, s37, 18874368
    buffer_load_dwordx4 v[220:223], v1, s[16:19], s37 offen offset:0 nt
    s_waitcnt vmcnt(27)
    v_mfma_f32_16x16x32_bf16 v[52:55], v[112:115], v[16:19], v[52:55]
    v_mfma_f32_16x16x32_bf16 v[56:59], v[112:115], v[20:23], v[56:59]
    v_mfma_f32_16x16x32_bf16 v[60:63], v[112:115], v[24:27], v[60:63]
    buffer_load_dwordx4 v[224:227], v1, s[16:19], s37 offen offset:128 nt
    s_waitcnt vmcnt(27)
    v_mfma_f32_16x16x32_bf16 v[52:55], v[116:119], v[28:31], v[52:55]
    v_mfma_f32_16x16x32_bf16 v[56:59], v[116:119], v[32:35], v[56:59]
    v_mfma_f32_16x16x32_bf16 v[60:63], v[116:119], v[36:39], v[60:63]
    buffer_load_dwordx4 v[228:231], v1, s[16:19], s100 offen offset:256 nt
    s_waitcnt vmcnt(27)
    v_mfma_f32_16x16x32_bf16 v[52:55], v[120:123], v[40:43], v[52:55]
    v_mfma_f32_16x16x32_bf16 v[56:59], v[120:123], v[44:47], v[56:59]
    v_mfma_f32_16x16x32_bf16 v[60:63], v[120:123], v[48:51], v[60:63]
    s_bitcmp1_b64 s[96:97], 42
    s_cselect_b32 s95, s99, s98
    s_add_u32 s95, s95, 88080384
    buffer_load_dwordx4 v[232:235], v1, s[16:19], s95 offen offset:0 nt
    s_cmp_lg_u32 s36, 7
    s_cbranch_scc1 L_nochk
    buffer_load_dword v14, v13, s[32:35], 0 offen offset:252 sc1
L_nochk:
    s_waitcnt vmcnt(27)
    v_mfma_f32_16x16x32_bf16 v[52:55], v[124:127], v[16:19], v[52:55]
    v_mfma_f32_16x16x32_bf16 v[56:59], v[124:127], v[20:23], v[56:59]
    v_mfma_f32_16x16x32_bf16 v[60:63], v[124:127], v[24:27], v[60:63]
    buffer_load_dwordx4 v[236:239], v1, s[16:19], s95 offen offset:128 nt
    s_waitcnt vmcnt(27)
    v_mfma_f32_16x16x32_bf16 v[52:55], v[128:131], v[28:31], v[52:55]
    v_mfma_f32_16x16x32_bf16 v[56:59], v[128:131], v[32:35], v[56:59]
    v_mfma_f32_16x16x32_bf16 v[60:63], v[128:131], v[36:39], v[60:63]
    buffer_load_dwordx4 v[240:243], v1, s[16:19], s95 offen offset:256 nt
    s_waitcnt vmcnt(27)
    v_mfma_f32_16x16x32_bf16 v[52:55], v[132:135], v[40:43], v[52:55]
    v_mfma_f32_16x16x32_bf16 v[56:59], v[132:135], v[44:47], v[56:59]
    v_mfma_f32_16x16x32_bf16 v[60:63], v[132:135], v[48:51], v[60:63]
    s_bitcmp1_b64 s[96:97], 45
    s_cselect_b32 s95, s99, s98
    s_add_u32 s95, s95, 94371840
    buffer_load_dwordx4 v[244:247], v1, s[16:19], s95 offen offset:0 nt
    s_waitcnt vmcnt(27)
    v_mfma_f32_16x16x32_bf16 v[52:55], v[136:139], v[16:19], v[52:55]
    v_mfma_f32_16x16x32_bf16 v[56:59], v[136:139], v[20:23], v[56:59]
    v_mfma_f32_16x16x32_bf16 v[60:63], v[136:139], v[24:27], v[60:63]
    buffer_load_dwordx4 v[248:251], v1, s[16:19], s95 offen offset:128 nt
    s_waitcnt vmcnt(27)
    v_mfma_f32_16x16x32_bf16 v[52:55], v[140:143], v[28:31], v[52:55]
    v_mfma_f32_16x16x32_bf16 v[56:59], v[140:143], v[32:35], v[56:59]
    v_mfma_f32_16x16x32_bf16 v[60:63], v[140:143], v[36:39], v[60:63]
    buffer_load_dwordx4 v[252:255], v1, s[16:19], s95 offen offset:256 nt
    s_waitcnt vmcnt(27)
    v_mfma_f32_16x16x32_bf16 v[52:55], v[144:147], v[40:43], v[52:55]
    v_mfma_f32_16x16x32_bf16 v[56:59], v[144:147], v[44:47], v[56:59]
    v_mfma_f32_16x16x32_bf16 v[60:63], v[144:147], v[48:51], v[60:63]
    buffer_load_dwordx4 v[4:7], v1, s[16:19], s101 offen offset:256 nt
    s_waitcnt vmcnt(27)
    v_mfma_f32_16x16x32_bf16 v[52:55], v[148:151], v[16:19], v[52:55]
    v_mfma_f32_16x16x32_bf16 v[56:59], v[148:151], v[20:23], v[56:59]
    v_mfma_f32_16x16x32_bf16 v[60:63], v[148:151], v[24:27], v[60:63]
    s_waitcnt vmcnt(26)
    v_mfma_f32_16x16x32_bf16 v[52:55], v[152:155], v[28:31], v[52:55]
    v_mfma_f32_16x16x32_bf16 v[56:59], v[152:155], v[32:35], v[56:59]
    v_mfma_f32_16x16x32_bf16 v[60:63], v[152:155], v[36:39], v[60:63]
    s_waitcnt vmcnt(25)
    v_mfma_f32_16x16x32_bf16 v[52:55], v[156:159], v[40:43], v[52:55]
    v_mfma_f32_16x16x32_bf16 v[56:59], v[156:159], v[44:47], v[56:59]
    v_mfma_f32_16x16x32_bf16 v[60:63], v[156:159], v[48:51], v[60:63]
    s_waitcnt vmcnt(24)
    v_mfma_f32_16x16x32_bf16 v[52:55], v[160:163], v[16:19], v[52:55]
    v_mfma_f32_16x16x32_bf16 v[56:59], v[160:163], v[20:23], v[56:59]
    v_mfma_f32_16x16x32_bf16 v[60:63], v[160:163], v[24:27], v[60:63]
    s_waitcnt vmcnt(23)
    v_mfma_f32_16x16x32_bf16 v[52:55], v[164:167], v[28:31], v[52:55]
    v_mfma_f32_16x16x32_bf16 v[56:59], v[164:167], v[32:35], v[56:59]
    v_mfma_f32_16x16x32_bf16 v[60:63], v[164:167], v[36:39], v[60:63]
    s_waitcnt vmcnt(22)
    v_mfma_f32_16x16x32_bf16 v[52:55], v[168:171], v[40:43], v[52:55]
    v_mfma_f32_16x16x32_bf16 v[56:59], v[168:171], v[44:47], v[56:59]
    v_mfma_f32_16x16x32_bf16 v[60:63], v[168:171], v[48:51], v[60:63]
    s_waitcnt vmcnt(21)
    v_mfma_f32_16x16x32_bf16 v[52:55], v[172:175], v[16:19], v[52:55]
    v_mfma_f32_16x16x32_bf16 v[56:59], v[172:175], v[20:23], v[56:59]
    v_mfma_f32_16x16x32_bf16 v[60:63], v[172:175], v[24:27], v[60:63]
    s_waitcnt vmcnt(20)
    v_mfma_f32_16x16x32_bf16 v[52:55], v[176:179], v[28:31], v[52:55]
    v_mfma_f32_16x16x32_bf16 v[56:59], v[176:179], v[32:35], v[56:59]
    v_mfma_f32_16x16x32_bf16 v[60:63], v[176:179], v[36:39], v[60:63]
    s_waitcnt vmcnt(19)
    v_mfma_f32_16x16x32_bf16 v[52:55], v[180:183], v[40:43], v[52:55]
    v_mfma_f32_16x16x32_bf16 v[56:59], v[180:183], v[44:47], v[56:59]
    v_mfma_f32_16x16x32_bf16 v[60:63], v[180:183], v[48:51], v[60:63]
    s_waitcnt vmcnt(18)
    v_mfma_f32_16x16x32_bf16 v[52:55], v[184:187], v[16:19], v[52:55]
    v_mfma_f32_16x16x32_bf16 v[56:59], v[184:187], v[20:23], v[56:59]
    v_mfma_f32_16x16x32_bf16 v[60:63], v[184:187], v[24:27], v[60:63]
    s_waitcnt vmcnt(17)
    v_mfma_f32_16x16x32_bf16 v[52:55], v[188:191], v[28:31], v[52:55]
    v_mfma_f32_16x16x32_bf16 v[56:59], v[188:191], v[32:35], v[56:59]
    v_mfma_f32_16x16x32_bf16 v[60:63], v[188:191], v[36:39], v[60:63]
    s_waitcnt vmcnt(16)
    v_mfma_f32_16x16x32_bf16 v[52:55], v[192:195], v[40:43], v[52:55]
    v_mfma_f32_16x16x32_bf16 v[56:59], v[192:195], v[44:47], v[56:59]
    v_mfma_f32_16x16x32_bf16 v[60:63], v[192:195], v[48:51], v[60:63]
    s_waitcnt vmcnt(15)
    v_mfma_f32_16x16x32_bf16 v[52:55], v[196:199], v[16:19], v[52:55]
    v_mfma_f32_16x16x32_bf16 v[56:59], v[196:199], v[20:23], v[56:59]
    v_mfma_f32_16x16x32_bf16 v[60:63], v[196:199], v[24:27], v[60:63]
    s_waitcnt vmcnt(14)
    v_mfma_f32_16x16x32_bf16 v[52:55], v[200:203], v[28:31], v[52:55]
    v_mfma_f32_16x16x32_bf16 v[56:59], v[200:203], v[32:35], v[56:59]
    v_mfma_f32_16x16x32_bf16 v[60:63], v[200:203], v[36:39], v[60:63]
    s_waitcnt vmcnt(13)
    v_mfma_f32_16x16x32_bf16 v[52:55], v[204:207], v[40:43], v[52:55]
    v_mfma_f32_16x16x32_bf16 v[56:59], v[204:207], v[44:47], v[56:59]
    v_mfma_f32_16x16x32_bf16 v[60:63], v[204:207], v[48:51], v[60:63]
    s_waitcnt vmcnt(12)
    v_mfma_f32_16x16x32_bf16 v[52:55], v[208:211], v[16:19], v[52:55]
    v_mfma_f32_16x16x32_bf16 v[56:59], v[208:211], v[20:23], v[56:59]
    v_mfma_f32_16x16x32_bf16 v[60:63], v[208:211], v[24:27], v[60:63]
    s_waitcnt vmcnt(11)
    v_mfma_f32_16x16x32_bf16 v[52:55], v[212:215], v[28:31], v[52:55]
    v_mfma_f32_16x16x32_bf16 v[56:59], v[212:215], v[32:35], v[56:59]
    v_mfma_f32_16x16x32_bf16 v[60:63], v[212:215], v[36:39], v[60:63]
    s_waitcnt vmcnt(10)
    v_mfma_f32_16x16x32_bf16 v[52:55], v[216:219], v[40:43], v[52:55]
    v_mfma_f32_16x16x32_bf16 v[56:59], v[216:219], v[44:47], v[56:59]
    v_mfma_f32_16x16x32_bf16 v[60:63], v[216:219], v[48:51], v[60:63]
    s_waitcnt vmcnt(9)
    v_mfma_f32_16x16x32_bf16 v[52:55], v[220:223], v[16:19], v[52:55]
    v_mfma_f32_16x16x32_bf16 v[56:59], v[220:223], v[20:23], v[56:59]
    v_mfma_f32_16x16x32_bf16 v[60:63], v[220:223], v[24:27], v[60:63]
    s_waitcnt vmcnt(8)
    v_mfma_f32_16x16x32_bf16 v[52:55], v[224:227], v[28:31], v[52:55]
    v_mfma_f32_16x16x32_bf16 v[56:59], v[224:227], v[32:35], v[56:59]
    v_mfma_f32_16x16x32_bf16 v[60:63], v[224:227], v[36:39], v[60:63]
    s_waitcnt vmcnt(7)
    v_mfma_f32_16x16x32_bf16 v[52:55], v[228:231], v[40:43], v[52:55]
    v_mfma_f32_16x16x32_bf16 v[56:59], v[228:231], v[44:47], v[56:59]
    v_mfma_f32_16x16x32_bf16 v[60:63], v[228:231], v[48:51], v[60:63]
    s_waitcnt vmcnt(6)
    v_mfma_f32_16x16x32_bf16 v[52:55], v[232:235], v[16:19], v[52:55]
    v_mfma_f32_16x16x32_bf16 v[56:59], v[232:235], v[20:23], v[56:59]
    v_mfma_f32_16x16x32_bf16 v[60:63], v[232:235], v[24:27], v[60:63]
    s_waitcnt vmcnt(5)
    v_mfma_f32_16x16x32_bf16 v[52:55], v[236:239], v[28:31], v[52:55]
    v_mfma_f32_16x16x32_bf16 v[56:59], v[236:239], v[32:35], v[56:59]
    v_mfma_f32_16x16x32_bf16 v[60:63], v[236:239], v[36:39], v[60:63]
    s_waitcnt vmcnt(4)
    v_mfma_f32_16x16x32_bf16 v[52:55], v[240:243], v[40:43], v[52:55]
    v_mfma_f32_16x16x32_bf16 v[56:59], v[240:243], v[44:47], v[56:59]
    v_mfma_f32_16x16x32_bf16 v[60:63], v[240:243], v[48:51], v[60:63]
    s_waitcnt vmcnt(3)
    v_mfma_f32_16x16x32_bf16 v[52:55], v[244:247], v[16:19], v[52:55]
    v_mfma_f32_16x16x32_bf16 v[56:59], v[244:247], v[20:23], v[56:59]
    v_mfma_f32_16x16x32_bf16 v[60:63], v[244:247], v[24:27], v[60:63]
    s_waitcnt vmcnt(2)
    v_mfma_f32_16x16x32_bf16 v[52:55], v[248:251], v[28:31], v[52:55]
    v_mfma_f32_16x16x32_bf16 v[56:59], v[248:251], v[32:35], v[56:59]
    v_mfma_f32_16x16x32_bf16 v[60:63], v[248:251], v[36:39], v[60:63]
    s_waitcnt vmcnt(1)
    v_mfma_f32_16x16x32_bf16 v[52:55], v[252:255], v[40:43], v[52:55]
    v_mfma_f32_16x16x32_bf16 v[56:59], v[252:255], v[44:47], v[56:59]
    v_mfma_f32_16x16x32_bf16 v[60:63], v[252:255], v[48:51], v[60:63]
    s_waitcnt vmcnt(0)
    v_mfma_f32_16x16x32_bf16 v[52:55], v[4:7], v[40:43], v[52:55]
    v_mfma_f32_16x16x32_bf16 v[56:59], v[4:7], v[44:47], v[56:59]
    v_mfma_f32_16x16x32_bf16 v[60:63], v[4:7], v[48:51], v[60:63]
    s_nop 7
    v_add_f32_dpp v52, v53, v52 row_shl:4 row_mask:0xf bank_mask:0xf
    v_add_f32_dpp v56, v57, v56 row_shl:4 row_mask:0xf bank_mask:0xf
    v_add_f32_dpp v60, v61, v60 row_shl:4 row_mask:0xf bank_mask:0xf
    v_add_f32_dpp v52, v54, v52 row_shl:8 row_mask:0xf bank_mask:0xf
    v_add_f32_dpp v56, v58, v56 row_shl:8 row_mask:0xf bank_mask:0xf
    v_add_f32_dpp v60, v62, v60 row_shl:8 row_mask:0xf bank_mask:0xf
    v_add_f32_dpp v52, v55, v52 row_shl:12 row_mask:0xf bank_mask:0xf
    v_add_f32_dpp v56, v59, v56 row_shl:12 row_mask:0xf bank_mask:0xf
    v_add_f32_dpp v60, v63, v60 row_shl:12 row_mask:0xf bank_mask:0xf
    s_mov_b32 exec_lo, 0x000f000f
    s_mov_b32 exec_hi, 0x000f000f
    ds_write_b32 v11, v52 offset:18432
    ds_write_b32 v11, v56 offset:19008
    ds_write_b32 v11, v60 offset:19584
    s_mov_b64 exec, -1
    s_cmp_lg_u32 s36, 7
    s_cbranch_scc1 L_others
    v_cmp_eq_u32 vcc, 0, v14
    s_cbranch_vccnz L_notready
L_ready:
    s_waitcnt lgkmcnt(0)
    s_barrier
    ds_read_b128 v[16:19], v12 offset:18432
    ds_read_b128 v[20:23], v12 offset:18448
    ds_read_b32 v24, v13 offset:22016
    s_waitcnt lgkmcnt(0)
    v_pk_add_f32 v[16:17], v[16:17], v[18:19]
    v_pk_add_f32 v[20:21], v[20:21], v[22:23]
    v_pk_add_f32 v[16:17], v[16:17], v[20:21]
    v_add_f32 v16, v16, v17
    v_or_b32 v24, v2, v24
    s_nop 0
    v_add_f32_dpp v16, v16, v16 quad_perm:[1,0,3,2] row_mask:0xf bank_mask:0xf
    s_nop 1
    v_add_f32_dpp v16, v16, v16 quad_perm:[2,3,0,1] row_mask:0xf bank_mask:0xf
    v_cndmask_b32 v16, v16, v24, s[10:11]
    s_mov_b32 exec_lo, 0x11111111
    s_mov_b32 exec_hi, 0x11111111
    v_min_u32 v16, -2, v16
    buffer_store_dword v16, v8, s[40:43], s44 offen sc1
    s_mov_b64 exec, -1
    v_lshlrev_b32 v15, 1, v3
    ds_read_u16 v34, v15 offset:4608
    ds_read_u16 v35, v15 offset:4992
    ds_read_u16 v36, v15 offset:5376
    ds_read_u16 v37, v15 offset:5760
    ds_read_u16 v38, v15 offset:6144
    ds_read_u16 v39, v15 offset:6528
    ds_read_u16 v40, v15 offset:6912
    ds_read_u16 v41, v15 offset:7296
    ds_read_u16 v42, v15 offset:7680
    ds_read_u16 v43, v15 offset:8064
    ds_read_u16 v44, v15 offset:8448
    ds_read_u16 v45, v15 offset:8832
    s_waitcnt lgkmcnt(0)
    v_lshl_or_b32 v16, v35, 16, v34
    v_lshl_or_b32 v17, v38, 16, v37
    v_lshl_or_b32 v18, v41, 16, v40
    v_lshl_or_b32 v19, v44, 16, v43
    v_lshl_or_b32 v20, v39, 16, v36
    v_lshl_or_b32 v21, v45, 16, v42
    ds_read_u16 v34, v15 offset:4736
    ds_read_u16 v35, v15 offset:5120
    ds_read_u16 v36, v15 offset:5504
    ds_read_u16 v37, v15 offset:5888
    ds_read_u16 v38, v15 offset:6272
    ds_read_u16 v39, v15 offset:6656
    ds_read_u16 v40, v15 offset:7040
    ds_read_u16 v41, v15 offset:7424
    ds_read_u16 v42, v15 offset:7808
    ds_read_u16 v43, v15 offset:8192
    ds_read_u16 v44, v15 offset:8576
    ds_read_u16 v45, v15 offset:8960
    s_waitcnt lgkmcnt(0)
    v_lshl_or_b32 v22, v35, 16, v34
    v_lshl_or_b32 v23, v38, 16, v37
    v_lshl_or_b32 v24, v41, 16, v40
    v_lshl_or_b32 v25, v44, 16, v43
    v_lshl_or_b32 v26, v39, 16, v36
    v_lshl_or_b32 v27, v45, 16, v42
    ds_read_u16 v34, v15 offset:4864
    ds_read_u16 v35, v15 offset:5248
    ds_read_u16 v36, v15 offset:5632
    ds_read_u16 v37, v15 offset:6016
    ds_read_u16 v38, v15 offset:6400
    ds_read_u16 v39, v15 offset:6784
    ds_read_u16 v40, v15 offset:7168
    ds_read_u16 v41, v15 offset:7552
    ds_read_u16 v42, v15 offset:7936
    ds_read_u16 v43, v15 offset:8320
    ds_read_u16 v44, v15 offset:8704
    ds_read_u16 v45, v15 offset:9088
    s_waitcnt lgkmcnt(0)
    v_lshl_or_b32 v28, v35, 16, v34
    v_lshl_or_b32 v29, v38, 16, v37
    v_lshl_or_b32 v30, v41, 16, v40
    v_lshl_or_b32 v31, v44, 16, v43
    v_lshl_or_b32 v32, v39, 16, v36
    v_lshl_or_b32 v33, v45, 16, v42
    s_mov_b32 s12, 0x0f000f00
    s_mov_b32 s13, 0x0f000f00
    s_mov_b32 s14, 0x00f000f0
    s_mov_b32 s15, 0x00f000f0
    s_mov_b32 s46, 0x36800000
    s_mov_b32 s47, 0xbfb8aa3b
    v_lshlrev_b32 v35, 2, v3
    s_mov_b32 s50, 4000
L_poll:
    s_mov_b32 s51, s93
    buffer_load_dwordx4 v[36:39], v9, s[40:43], s51 offen offset:0 sc1
    buffer_load_dwordx4 v[40:43], v9, s[40:43], s51 offen offset:1024 sc1
    buffer_load_dwordx4 v[44:47], v9, s[40:43], s51 offen offset:2048 sc1
    buffer_load_dwordx4 v[48:51], v9, s[40:43], s51 offen offset:3072 sc1
    s_add_u32 s51, s51, 4096
    buffer_load_dwordx4 v[52:55], v9, s[40:43], s51 offen offset:0 sc1
    buffer_load_dwordx4 v[56:59], v9, s[40:43], s51 offen offset:1024 sc1
    buffer_load_dwordx4 v[60:63], v9, s[40:43], s51 offen offset:2048 sc1
    s_waitcnt vmcnt(6)
    v_mov_b32 v12, v36
    v_mov_b32 v13, v37
    v_mov_b32 v14, v38
    v_max3_u32 v15, v36, v37, v38
    v_xor_b32 v34, v39, v2
    buffer_load_dwordx4 v[36:39], v9, s[40:43], s51 offen offset:3072 sc1
    s_waitcnt vmcnt(6)
    v_max3_u32 v15, v15, v40, v41
    v_max_u32 v15, v15, v42
    v_pk_add_f32 v[12:13], v[12:13], v[40:41]
    v_add_f32 v14, v14, v42
    v_bitop3_b32 v34, v34, v43, v2 bitop3:0xf6
    s_add_u32 s51, s51, 4096
    buffer_load_dwordx4 v[40:43], v9, s[40:43], s51 offen offset:0 sc1
    s_waitcnt vmcnt(6)
    v_max3_u32 v15, v15, v44, v45
    v_max_u32 v15, v15, v46
    v_pk_add_f32 v[12:13], v[12:13], v[44:45]
    v_add_f32 v14, v14, v46
    v_bitop3_b32 v34, v34, v47, v2 bitop3:0xf6
    buffer_load_dwordx4 v[44:47], v9, s[40:43], s51 offen offset:1024 sc1
    s_waitcnt vmcnt(6)
    v_max3_u32 v15, v15, v48, v49
    v_max_u32 v15, v15, v50
    v_pk_add_f32 v[12:13], v[12:13], v[48:49]
    v_add_f32 v14, v14, v50
    v_bitop3_b32 v34, v34, v51, v2 bitop3:0xf6
    buffer_load_dwordx4 v[48:51], v9, s[40:43], s51 offen offset:2048 sc1
    s_waitcnt vmcnt(6)
    v_max3_u32 v15, v15, v52, v53
    v_max_u32 v15, v15, v54
    v_pk_add_f32 v[12:13], v[12:13], v[52:53]
    v_add_f32 v14, v14, v54
    v_bitop3_b32 v34, v34, v55, v2 bitop3:0xf6
    buffer_load_dwordx4 v[52:55], v9, s[40:43], s51 offen offset:3072 sc1
    s_waitcnt vmcnt(6)
    v_max3_u32 v15, v15, v56, v57
    v_max_u32 v15, v15, v58
    v_pk_add_f32 v[12:13], v[12:13], v[56:57]
    v_add_f32 v14, v14, v58
    v_bitop3_b32 v34, v34, v59, v2 bitop3:0xf6
    s_add_u32 s51, s51, 4096
    buffer_load_dwordx4 v[56:59], v9, s[40:43], s51 offen offset:0 sc1
    s_waitcnt vmcnt(6)
    v_max3_u32 v15, v15, v60, v61
    v_max_u32 v15, v15, v62
    v_pk_add_f32 v[12:13], v[12:13], v[60:61]
    v_add_f32 v14, v14, v62
    v_bitop3_b32 v34, v34, v63, v2 bitop3:0xf6
    buffer_load_dwordx4 v[60:63], v9, s[40:43], s51 offen offset:1024 sc1
    s_waitcnt vmcnt(6)
    v_max3_u32 v15, v15, v36, v37
    v_max_u32 v15, v15, v38
    v_pk_add_f32 v[12:13], v[12:13], v[36:37]
    v_add_f32 v14, v14, v38
    v_bitop3_b32 v34, v34, v39, v2 bitop3:0xf6
    buffer_load_dwordx4 v[36:39], v9, s[40:43], s51 offen offset:2048 sc1
    s_waitcnt vmcnt(6)
    v_max3_u32 v15, v15, v40, v41
    v_max_u32 v15, v15, v42
    v_pk_add_f32 v[12:13], v[12:13], v[40:41]
    v_add_f32 v14, v14, v42
    v_bitop3_b32 v34, v34, v43, v2 bitop3:0xf6
    buffer_load_dwordx4 v[40:43], v9, s[40:43], s51 offen offset:3072 sc1
    s_waitcnt vmcnt(6)
    v_max3_u32 v15, v15, v44, v45
    v_max_u32 v15, v15, v46
    v_pk_add_f32 v[12:13], v[12:13], v[44:45]
    v_add_f32 v14, v14, v46
    v_bitop3_b32 v34, v34, v47, v2 bitop3:0xf6
    s_waitcnt vmcnt(5)
    v_max3_u32 v15, v15, v48, v49
    v_max_u32 v15, v15, v50
    v_pk_add_f32 v[12:13], v[12:13], v[48:49]
    v_add_f32 v14, v14, v50
    v_bitop3_b32 v34, v34, v51, v2 bitop3:0xf6
    s_waitcnt vmcnt(4)
    v_max3_u32 v15, v15, v52, v53
    v_max_u32 v15, v15, v54
    v_pk_add_f32 v[12:13], v[12:13], v[52:53]
    v_add_f32 v14, v14, v54
    v_bitop3_b32 v34, v34, v55, v2 bitop3:0xf6
    s_waitcnt vmcnt(3)
    v_max3_u32 v15, v15, v56, v57
    v_max_u32 v15, v15, v58
    v_pk_add_f32 v[12:13], v[12:13], v[56:57]
    v_add_f32 v14, v14, v58
    v_bitop3_b32 v34, v34, v59, v2 bitop3:0xf6
    s_waitcnt vmcnt(2)
    v_max3_u32 v15, v15, v60, v61
    v_max_u32 v15, v15, v62
    v_pk_add_f32 v[12:13], v[12:13], v[60:61]
    v_add_f32 v14, v14, v62
    v_bitop3_b32 v34, v34, v63, v2 bitop3:0xf6
    s_waitcnt vmcnt(1)
    v_max3_u32 v15, v15, v36, v37
    v_max_u32 v15, v15, v38
    v_pk_add_f32 v[12:13], v[12:13], v[36:37]
    v_add_f32 v14, v14, v38
    v_bitop3_b32 v34, v34, v39, v2 bitop3:0xf6
    s_waitcnt vmcnt(0)
    v_max3_u32 v15, v15, v40, v41
    v_max_u32 v15, v15, v42
    v_cmp_eq_u32 vcc, -1, v15
    s_cbranch_vccnz L_poll_again
L_poll_done:
    v_pk_add_f32 v[12:13], v[12:13], v[40:41]
    v_add_f32 v14, v14, v42
    v_bitop3_b32 v34, v34, v43, v2 bitop3:0xf6
    v_cmp_ne_u32 vcc, 0, v34
    s_cbranch_vccnz L_mismatch
L_mlp:
    v_add_f32_dpp v12, v12, v12 row_ror:8 row_mask:0xf bank_mask:0xf
    v_add_f32_dpp v13, v13, v13 row_ror:8 row_mask:0xf bank_mask:0xf
    v_add_f32_dpp v14, v14, v14 row_ror:8 row_mask:0xf bank_mask:0xf
    v_add_f32_dpp v12, v12, v12 row_ror:4 row_mask:0xf bank_mask:0xf
    v_add_f32_dpp v13, v13, v13 row_ror:4 row_mask:0xf bank_mask:0xf
    v_add_f32_dpp v14, v14, v14 row_ror:4 row_mask:0xf bank_mask:0xf
    v_cndmask_b32 v12, v12, v13, s[14:15]
    v_cndmask_b32 v12, v12, v14, s[12:13]
    v_mov_b32 v36, v12
    s_nop 1
    v_permlane32_swap_b32 v12, v36
    s_nop 0
    v_add_f32 v12, v12, v36
    v_mov_b32 v36, v12
    s_nop 1
    v_permlane16_swap_b32 v12, v36
    s_nop 0
    v_add_f32 v12, v12, v36
    v_mul_f32 v12, s46, v12
    v_cvt_pk_bf16_f32 v12, v12, v12
    v_and_b32 v12, s39, v12
    v_mul_f32 v36, s47, v12
    v_exp_f32 v36, v36
    s_nop 0
    v_add_f32 v36, 1.0, v36
    v_rcp_f32 v36, v36
    s_nop 0
    v_mul_f32 v12, v12, v36
    s_nop 1
    v_mov_b32_dpp v36, v12 row_shl:4 row_mask:0xf bank_mask:0xf
    v_mov_b32_dpp v37, v12 quad_perm:[1,1,3,3] row_mask:0xf bank_mask:0xf
    v_cvt_pk_bf16_f32 v36, v12, v36
    v_cvt_pk_bf16_f32 v37, v12, v37
    v_readlane_b32 s76, v36, 0
    v_readlane_b32 s77, v36, 1
    v_readlane_b32 s78, v36, 2
    v_readlane_b32 s79, v36, 3
    v_readlane_b32 s80, v37, 8
    v_readlane_b32 s81, v37, 10
    v_dot2_f32_bf16 v36, s76, v16, 0
    v_dot2_f32_bf16 v37, s76, v22, 0
    v_dot2_f32_bf16 v38, s76, v28, 0
    v_dot2_f32_bf16 v36, s77, v17, v36
    v_dot2_f32_bf16 v37, s77, v23, v37
    v_dot2_f32_bf16 v38, s77, v29, v38
    v_dot2_f32_bf16 v36, s78, v18, v36
    v_dot2_f32_bf16 v37, s78, v24, v37
    v_dot2_f32_bf16 v38, s78, v30, v38
    v_dot2_f32_bf16 v36, s79, v19, v36
    v_dot2_f32_bf16 v37, s79, v25, v37
    v_dot2_f32_bf16 v38, s79, v31, v38
    v_dot2_f32_bf16 v36, s80, v20, v36
    v_dot2_f32_bf16 v37, s80, v26, v37
    v_dot2_f32_bf16 v38, s80, v32, v38
    v_dot2_f32_bf16 v36, s81, v21, v36
    v_dot2_f32_bf16 v37, s81, v27, v37
    v_dot2_f32_bf16 v38, s81, v33, v38
    s_nop 1
    v_cvt_pk_bf16_f32 v36, v36, v36
    v_cvt_pk_bf16_f32 v37, v37, v37
    v_cvt_pk_bf16_f32 v38, v38, v38
    v_and_b32 v36, s39, v36
    v_and_b32 v37, s39, v37
    v_and_b32 v38, s39, v38
    v_mul_f32 v36, s47, v36
    v_mul_f32 v37, s47, v37
    v_mul_f32 v38, s47, v38
    v_exp_f32 v36, v36
    v_exp_f32 v37, v37
    v_exp_f32 v38, v38
    s_nop 0
    v_add_f32 v36, 1.0, v36
    v_add_f32 v37, 1.0, v37
    v_add_f32 v38, 1.0, v38
    v_rcp_f32 v36, v36
    v_rcp_f32 v37, v37
    v_rcp_f32 v38, v38
    s_nop 0
    v_cvt_pk_bf16_f32 v36, v36, v36
    v_cvt_pk_bf16_f32 v37, v37, v37
    v_cvt_pk_bf16_f32 v38, v38, v38
    v_and_b32 v36, s39, v36
    v_and_b32 v37, s39, v37
    v_and_b32 v38, s39, v38
    ds_write_b32 v35, v36 offset:20992
    ds_write_b32 v35, v37 offset:21248
    ds_write_b32 v35, v38 offset:21504
    s_waitcnt lgkmcnt(0)
L_wait_s:
    s_barrier
    ds_read_b128 v[16:19], v10 offset:20992
    ds_read_b128 v[20:23], v10 offset:21008
    ds_read_b128 v[24:27], v10 offset:21248
    ds_read_b128 v[28:31], v10 offset:21264
    ds_read_b128 v[32:35], v10 offset:21504
    ds_read_b128 v[36:39], v10 offset:21520
    v_lshlrev_b32 v40, 16, v64
    v_and_b32 v41, s39, v64
    v_lshlrev_b32 v42, 16, v65
    v_and_b32 v43, s39, v65
    v_lshlrev_b32 v44, 16, v66
    v_and_b32 v45, s39, v66
    v_lshlrev_b32 v46, 16, v67
    v_and_b32 v47, s39, v67
    s_waitcnt lgkmcnt(4)
    v_cmp_gt_f32 vcc, 0, v16
    s_cbranch_vccnz L_restart
    v_pk_mul_f32 v[40:41], v[40:41], v[16:17]
    v_pk_mul_f32 v[42:43], v[42:43], v[18:19]
    v_pk_mul_f32 v[44:45], v[44:45], v[20:21]
    v_pk_mul_f32 v[46:47], v[46:47], v[22:23]
    v_cvt_pk_bf16_f32 v64, v40, v41
    v_cvt_pk_bf16_f32 v65, v42, v43
    v_cvt_pk_bf16_f32 v66, v44, v45
    v_cvt_pk_bf16_f32 v67, v46, v47
    buffer_store_dwordx4 v[64:67], v1, s[20:23], s56 offen offset:0 sc1
    v_lshlrev_b32 v48, 16, v68
    v_and_b32 v49, s39, v68
    v_lshlrev_b32 v50, 16, v69
    v_and_b32 v51, s39, v69
    v_lshlrev_b32 v52, 16, v70
    v_and_b32 v53, s39, v70
    v_lshlrev_b32 v54, 16, v71
    v_and_b32 v55, s39, v71
    s_waitcnt lgkmcnt(2)
    v_pk_mul_f32 v[48:49], v[48:49], v[24:25]
    v_pk_mul_f32 v[50:51], v[50:51], v[26:27]
    v_pk_mul_f32 v[52:53], v[52:53], v[28:29]
    v_pk_mul_f32 v[54:55], v[54:55], v[30:31]
    v_cvt_pk_bf16_f32 v68, v48, v49
    v_cvt_pk_bf16_f32 v69, v50, v51
    v_cvt_pk_bf16_f32 v70, v52, v53
    v_cvt_pk_bf16_f32 v71, v54, v55
    buffer_store_dwordx4 v[68:71], v1, s[20:23], s56 offen offset:128 sc1
    v_lshlrev_b32 v40, 16, v72
    v_and_b32 v41, s39, v72
    v_lshlrev_b32 v42, 16, v73
    v_and_b32 v43, s39, v73
    v_lshlrev_b32 v44, 16, v74
    v_and_b32 v45, s39, v74
    v_lshlrev_b32 v46, 16, v75
    v_and_b32 v47, s39, v75
    s_waitcnt lgkmcnt(0)
    v_pk_mul_f32 v[40:41], v[40:41], v[32:33]
    v_pk_mul_f32 v[42:43], v[42:43], v[34:35]
    v_pk_mul_f32 v[44:45], v[44:45], v[36:37]
    v_pk_mul_f32 v[46:47], v[46:47], v[38:39]
    v_cvt_pk_bf16_f32 v72, v40, v41
    v_cvt_pk_bf16_f32 v73, v42, v43
    v_cvt_pk_bf16_f32 v74, v44, v45
    v_cvt_pk_bf16_f32 v75, v46, v47
    buffer_store_dwordx4 v[72:75], v1, s[20:23], s56 offen offset:256 sc1
    s_add_u32 s38, s56, 6291456
    v_lshlrev_b32 v48, 16, v76
    v_and_b32 v49, s39, v76
    v_lshlrev_b32 v50, 16, v77
    v_and_b32 v51, s39, v77
    v_lshlrev_b32 v52, 16, v78
    v_and_b32 v53, s39, v78
    v_lshlrev_b32 v54, 16, v79
    v_and_b32 v55, s39, v79
    v_pk_mul_f32 v[48:49], v[48:49], v[16:17]
    v_pk_mul_f32 v[50:51], v[50:51], v[18:19]
    v_pk_mul_f32 v[52:53], v[52:53], v[20:21]
    v_pk_mul_f32 v[54:55], v[54:55], v[22:23]
    v_cvt_pk_bf16_f32 v76, v48, v49
    v_cvt_pk_bf16_f32 v77, v50, v51
    v_cvt_pk_bf16_f32 v78, v52, v53
    v_cvt_pk_bf16_f32 v79, v54, v55
    buffer_store_dwordx4 v[76:79], v1, s[20:23], s38 offen offset:0 sc1
    v_lshlrev_b32 v40, 16, v80
    v_and_b32 v41, s39, v80
    v_lshlrev_b32 v42, 16, v81
    v_and_b32 v43, s39, v81
    v_lshlrev_b32 v44, 16, v82
    v_and_b32 v45, s39, v82
    v_lshlrev_b32 v46, 16, v83
    v_and_b32 v47, s39, v83
    v_pk_mul_f32 v[40:41], v[40:41], v[24:25]
    v_pk_mul_f32 v[42:43], v[42:43], v[26:27]
    v_pk_mul_f32 v[44:45], v[44:45], v[28:29]
    v_pk_mul_f32 v[46:47], v[46:47], v[30:31]
    v_cvt_pk_bf16_f32 v80, v40, v41
    v_cvt_pk_bf16_f32 v81, v42, v43
    v_cvt_pk_bf16_f32 v82, v44, v45
    v_cvt_pk_bf16_f32 v83, v46, v47
    buffer_store_dwordx4 v[80:83], v1, s[20:23], s38 offen offset:128 sc1
    v_lshlrev_b32 v48, 16, v84
    v_and_b32 v49, s39, v84
    v_lshlrev_b32 v50, 16, v85
    v_and_b32 v51, s39, v85
    v_lshlrev_b32 v52, 16, v86
    v_and_b32 v53, s39, v86
    v_lshlrev_b32 v54, 16, v87
    v_and_b32 v55, s39, v87
    v_pk_mul_f32 v[48:49], v[48:49], v[32:33]
    v_pk_mul_f32 v[50:51], v[50:51], v[34:35]
    v_pk_mul_f32 v[52:53], v[52:53], v[36:37]
    v_pk_mul_f32 v[54:55], v[54:55], v[38:39]
    v_cvt_pk_bf16_f32 v84, v48, v49
    v_cvt_pk_bf16_f32 v85, v50, v51
    v_cvt_pk_bf16_f32 v86, v52, v53
    v_cvt_pk_bf16_f32 v87, v54, v55
    buffer_store_dwordx4 v[84:87], v1, s[20:23], s38 offen offset:256 sc1
    s_add_u32 s38, s38, 6291456
    v_lshlrev_b32 v40, 16, v88
    v_and_b32 v41, s39, v88
    v_lshlrev_b32 v42, 16, v89
    v_and_b32 v43, s39, v89
    v_lshlrev_b32 v44, 16, v90
    v_and_b32 v45, s39, v90
    v_lshlrev_b32 v46, 16, v91
    v_and_b32 v47, s39, v91
    v_pk_mul_f32 v[40:41], v[40:41], v[16:17]
    v_pk_mul_f32 v[42:43], v[42:43], v[18:19]
    v_pk_mul_f32 v[44:45], v[44:45], v[20:21]
    v_pk_mul_f32 v[46:47], v[46:47], v[22:23]
    v_cvt_pk_bf16_f32 v88, v40, v41
    v_cvt_pk_bf16_f32 v89, v42, v43
    v_cvt_pk_bf16_f32 v90, v44, v45
    v_cvt_pk_bf16_f32 v91, v46, v47
    buffer_store_dwordx4 v[88:91], v1, s[20:23], s38 offen offset:0 sc1
    v_lshlrev_b32 v48, 16, v92
    v_and_b32 v49, s39, v92
    v_lshlrev_b32 v50, 16, v93
    v_and_b32 v51, s39, v93
    v_lshlrev_b32 v52, 16, v94
    v_and_b32 v53, s39, v94
    v_lshlrev_b32 v54, 16, v95
    v_and_b32 v55, s39, v95
    v_pk_mul_f32 v[48:49], v[48:49], v[24:25]
    v_pk_mul_f32 v[50:51], v[50:51], v[26:27]
    v_pk_mul_f32 v[52:53], v[52:53], v[28:29]
    v_pk_mul_f32 v[54:55], v[54:55], v[30:31]
    v_cvt_pk_bf16_f32 v92, v48, v49
    v_cvt_pk_bf16_f32 v93, v50, v51
    v_cvt_pk_bf16_f32 v94, v52, v53
    v_cvt_pk_bf16_f32 v95, v54, v55
    buffer_store_dwordx4 v[92:95], v1, s[20:23], s38 offen offset:128 sc1
    v_lshlrev_b32 v40, 16, v96
    v_and_b32 v41, s39, v96
    v_lshlrev_b32 v42, 16, v97
    v_and_b32 v43, s39, v97
    v_lshlrev_b32 v44, 16, v98
    v_and_b32 v45, s39, v98
    v_lshlrev_b32 v46, 16, v99
    v_and_b32 v47, s39, v99
    v_pk_mul_f32 v[40:41], v[40:41], v[32:33]
    v_pk_mul_f32 v[42:43], v[42:43], v[34:35]
    v_pk_mul_f32 v[44:45], v[44:45], v[36:37]
    v_pk_mul_f32 v[46:47], v[46:47], v[38:39]
    v_cvt_pk_bf16_f32 v96, v40, v41
    v_cvt_pk_bf16_f32 v97, v42, v43
    v_cvt_pk_bf16_f32 v98, v44, v45
    v_cvt_pk_bf16_f32 v99, v46, v47
    buffer_store_dwordx4 v[96:99], v1, s[20:23], s38 offen offset:256 sc1
    s_bitcmp1_b64 s[96:97], 33
    s_cselect_b32 s95, s99, s98
    s_add_u32 s95, s95, 69206016
    v_lshlrev_b32 v48, 16, v196
    v_and_b32 v49, s39, v196
    v_lshlrev_b32 v50, 16, v197
    v_and_b32 v51, s39, v197
    v_lshlrev_b32 v52, 16, v198
    v_and_b32 v53, s39, v198
    v_lshlrev_b32 v54, 16, v199
    v_and_b32 v55, s39, v199
    v_pk_mul_f32 v[48:49], v[48:49], v[16:17]
    v_pk_mul_f32 v[50:51], v[50:51], v[18:19]
    v_pk_mul_f32 v[52:53], v[52:53], v[20:21]
    v_pk_mul_f32 v[54:55], v[54:55], v[22:23]
    v_cvt_pk_bf16_f32 v196, v48, v49
    v_cvt_pk_bf16_f32 v197, v50, v51
    v_cvt_pk_bf16_f32 v198, v52, v53
    v_cvt_pk_bf16_f32 v199, v54, v55
    buffer_store_dwordx4 v[196:199], v1, s[20:23], s95 offen offset:0 sc1
    v_lshlrev_b32 v40, 16, v200
    v_and_b32 v41, s39, v200
    v_lshlrev_b32 v42, 16, v201
    v_and_b32 v43, s39, v201
    v_lshlrev_b32 v44, 16, v202
    v_and_b32 v45, s39, v202
    v_lshlrev_b32 v46, 16, v203
    v_and_b32 v47, s39, v203
    v_pk_mul_f32 v[40:41], v[40:41], v[24:25]
    v_pk_mul_f32 v[42:43], v[42:43], v[26:27]
    v_pk_mul_f32 v[44:45], v[44:45], v[28:29]
    v_pk_mul_f32 v[46:47], v[46:47], v[30:31]
    v_cvt_pk_bf16_f32 v200, v40, v41
    v_cvt_pk_bf16_f32 v201, v42, v43
    v_cvt_pk_bf16_f32 v202, v44, v45
    v_cvt_pk_bf16_f32 v203, v46, v47
    buffer_store_dwordx4 v[200:203], v1, s[20:23], s95 offen offset:128 sc1
    v_lshlrev_b32 v48, 16, v204
    v_and_b32 v49, s39, v204
    v_lshlrev_b32 v50, 16, v205
    v_and_b32 v51, s39, v205
    v_lshlrev_b32 v52, 16, v206
    v_and_b32 v53, s39, v206
    v_lshlrev_b32 v54, 16, v207
    v_and_b32 v55, s39, v207
    v_pk_mul_f32 v[48:49], v[48:49], v[32:33]
    v_pk_mul_f32 v[50:51], v[50:51], v[34:35]
    v_pk_mul_f32 v[52:53], v[52:53], v[36:37]
    v_pk_mul_f32 v[54:55], v[54:55], v[38:39]
    v_cvt_pk_bf16_f32 v204, v48, v49
    v_cvt_pk_bf16_f32 v205, v50, v51
    v_cvt_pk_bf16_f32 v206, v52, v53
    v_cvt_pk_bf16_f32 v207, v54, v55
    buffer_store_dwordx4 v[204:207], v1, s[20:23], s95 offen offset:256 sc1
    s_add_u32 s38, s38, 6291456
    v_lshlrev_b32 v40, 16, v100
    v_and_b32 v41, s39, v100
    v_lshlrev_b32 v42, 16, v101
    v_and_b32 v43, s39, v101
    v_lshlrev_b32 v44, 16, v102
    v_and_b32 v45, s39, v102
    v_lshlrev_b32 v46, 16, v103
    v_and_b32 v47, s39, v103
    v_pk_mul_f32 v[40:41], v[40:41], v[16:17]
    v_pk_mul_f32 v[42:43], v[42:43], v[18:19]
    v_pk_mul_f32 v[44:45], v[44:45], v[20:21]
    v_pk_mul_f32 v[46:47], v[46:47], v[22:23]
    v_cvt_pk_bf16_f32 v100, v40, v41
    v_cvt_pk_bf16_f32 v101, v42, v43
    v_cvt_pk_bf16_f32 v102, v44, v45
    v_cvt_pk_bf16_f32 v103, v46, v47
    buffer_store_dwordx4 v[100:103], v1, s[20:23], s38 offen offset:0 sc1
    v_lshlrev_b32 v48, 16, v104
    v_and_b32 v49, s39, v104
    v_lshlrev_b32 v50, 16, v105
    v_and_b32 v51, s39, v105
    v_lshlrev_b32 v52, 16, v106
    v_and_b32 v53, s39, v106
    v_lshlrev_b32 v54, 16, v107
    v_and_b32 v55, s39, v107
    v_pk_mul_f32 v[48:49], v[48:49], v[24:25]
    v_pk_mul_f32 v[50:51], v[50:51], v[26:27]
    v_pk_mul_f32 v[52:53], v[52:53], v[28:29]
    v_pk_mul_f32 v[54:55], v[54:55], v[30:31]
    v_cvt_pk_bf16_f32 v104, v48, v49
    v_cvt_pk_bf16_f32 v105, v50, v51
    v_cvt_pk_bf16_f32 v106, v52, v53
    v_cvt_pk_bf16_f32 v107, v54, v55
    buffer_store_dwordx4 v[104:107], v1, s[20:23], s38 offen offset:128 sc1
    v_lshlrev_b32 v40, 16, v108
    v_and_b32 v41, s39, v108
    v_lshlrev_b32 v42, 16, v109
    v_and_b32 v43, s39, v109
    v_lshlrev_b32 v44, 16, v110
    v_and_b32 v45, s39, v110
    v_lshlrev_b32 v46, 16, v111
    v_and_b32 v47, s39, v111
    v_pk_mul_f32 v[40:41], v[40:41], v[32:33]
    v_pk_mul_f32 v[42:43], v[42:43], v[34:35]
    v_pk_mul_f32 v[44:45], v[44:45], v[36:37]
    v_pk_mul_f32 v[46:47], v[46:47], v[38:39]
    v_cvt_pk_bf16_f32 v108, v40, v41
    v_cvt_pk_bf16_f32 v109, v42, v43
    v_cvt_pk_bf16_f32 v110, v44, v45
    v_cvt_pk_bf16_f32 v111, v46, v47
    buffer_store_dwordx4 v[108:111], v1, s[20:23], s38 offen offset:256 sc1
    s_add_u32 s38, s38, 6291456
    v_lshlrev_b32 v48, 16, v112
    v_and_b32 v49, s39, v112
    v_lshlrev_b32 v50, 16, v113
    v_and_b32 v51, s39, v113
    v_lshlrev_b32 v52, 16, v114
    v_and_b32 v53, s39, v114
    v_lshlrev_b32 v54, 16, v115
    v_and_b32 v55, s39, v115
    v_pk_mul_f32 v[48:49], v[48:49], v[16:17]
    v_pk_mul_f32 v[50:51], v[50:51], v[18:19]
    v_pk_mul_f32 v[52:53], v[52:53], v[20:21]
    v_pk_mul_f32 v[54:55], v[54:55], v[22:23]
    v_cvt_pk_bf16_f32 v112, v48, v49
    v_cvt_pk_bf16_f32 v113, v50, v51
    v_cvt_pk_bf16_f32 v114, v52, v53
    v_cvt_pk_bf16_f32 v115, v54, v55
    buffer_store_dwordx4 v[112:115], v1, s[20:23], s38 offen offset:0 sc1
    v_lshlrev_b32 v40, 16, v116
    v_and_b32 v41, s39, v116
    v_lshlrev_b32 v42, 16, v117
    v_and_b32 v43, s39, v117
    v_lshlrev_b32 v44, 16, v118
    v_and_b32 v45, s39, v118
    v_lshlrev_b32 v46, 16, v119
    v_and_b32 v47, s39, v119
    v_pk_mul_f32 v[40:41], v[40:41], v[24:25]
    v_pk_mul_f32 v[42:43], v[42:43], v[26:27]
    v_pk_mul_f32 v[44:45], v[44:45], v[28:29]
    v_pk_mul_f32 v[46:47], v[46:47], v[30:31]
    v_cvt_pk_bf16_f32 v116, v40, v41
    v_cvt_pk_bf16_f32 v117, v42, v43
    v_cvt_pk_bf16_f32 v118, v44, v45
    v_cvt_pk_bf16_f32 v119, v46, v47
    buffer_store_dwordx4 v[116:119], v1, s[20:23], s38 offen offset:128 sc1
    v_lshlrev_b32 v48, 16, v120
    v_and_b32 v49, s39, v120
    v_lshlrev_b32 v50, 16, v121
    v_and_b32 v51, s39, v121
    v_lshlrev_b32 v52, 16, v122
    v_and_b32 v53, s39, v122
    v_lshlrev_b32 v54, 16, v123
    v_and_b32 v55, s39, v123
    v_pk_mul_f32 v[48:49], v[48:49], v[32:33]
    v_pk_mul_f32 v[50:51], v[50:51], v[34:35]
    v_pk_mul_f32 v[52:53], v[52:53], v[36:37]
    v_pk_mul_f32 v[54:55], v[54:55], v[38:39]
    v_cvt_pk_bf16_f32 v120, v48, v49
    v_cvt_pk_bf16_f32 v121, v50, v51
    v_cvt_pk_bf16_f32 v122, v52, v53
    v_cvt_pk_bf16_f32 v123, v54, v55
    buffer_store_dwordx4 v[120:123], v1, s[20:23], s38 offen offset:256 sc1
    s_add_u32 s38, s38, 6291456
    v_lshlrev_b32 v40, 16, v124
    v_and_b32 v41, s39, v124
    v_lshlrev_b32 v42, 16, v125
    v_and_b32 v43, s39, v125
    v_lshlrev_b32 v44, 16, v126
    v_and_b32 v45, s39, v126
    v_lshlrev_b32 v46, 16, v127
    v_and_b32 v47, s39, v127
    v_pk_mul_f32 v[40:41], v[40:41], v[16:17]
    v_pk_mul_f32 v[42:43], v[42:43], v[18:19]
    v_pk_mul_f32 v[44:45], v[44:45], v[20:21]
    v_pk_mul_f32 v[46:47], v[46:47], v[22:23]
    v_cvt_pk_bf16_f32 v124, v40, v41
    v_cvt_pk_bf16_f32 v125, v42, v43
    v_cvt_pk_bf16_f32 v126, v44, v45
    v_cvt_pk_bf16_f32 v127, v46, v47
    buffer_store_dwordx4 v[124:127], v1, s[20:23], s38 offen offset:0 sc1
    v_lshlrev_b32 v48, 16, v128
    v_and_b32 v49, s39, v128
    v_lshlrev_b32 v50, 16, v129
    v_and_b32 v51, s39, v129
    v_lshlrev_b32 v52, 16, v130
    v_and_b32 v53, s39, v130
    v_lshlrev_b32 v54, 16, v131
    v_and_b32 v55, s39, v131
    v_pk_mul_f32 v[48:49], v[48:49], v[24:25]
    v_pk_mul_f32 v[50:51], v[50:51], v[26:27]
    v_pk_mul_f32 v[52:53], v[52:53], v[28:29]
    v_pk_mul_f32 v[54:55], v[54:55], v[30:31]
    v_cvt_pk_bf16_f32 v128, v48, v49
    v_cvt_pk_bf16_f32 v129, v50, v51
    v_cvt_pk_bf16_f32 v130, v52, v53
    v_cvt_pk_bf16_f32 v131, v54, v55
    buffer_store_dwordx4 v[128:131], v1, s[20:23], s38 offen offset:128 sc1
    v_lshlrev_b32 v40, 16, v132
    v_and_b32 v41, s39, v132
    v_lshlrev_b32 v42, 16, v133
    v_and_b32 v43, s39, v133
    v_lshlrev_b32 v44, 16, v134
    v_and_b32 v45, s39, v134
    v_lshlrev_b32 v46, 16, v135
    v_and_b32 v47, s39, v135
    v_pk_mul_f32 v[40:41], v[40:41], v[32:33]
    v_pk_mul_f32 v[42:43], v[42:43], v[34:35]
    v_pk_mul_f32 v[44:45], v[44:45], v[36:37]
    v_pk_mul_f32 v[46:47], v[46:47], v[38:39]
    v_cvt_pk_bf16_f32 v132, v40, v41
    v_cvt_pk_bf16_f32 v133, v42, v43
    v_cvt_pk_bf16_f32 v134, v44, v45
    v_cvt_pk_bf16_f32 v135, v46, v47
    buffer_store_dwordx4 v[132:135], v1, s[20:23], s38 offen offset:256 sc1
    s_bitcmp1_b64 s[96:97], 36
    s_cselect_b32 s95, s99, s98
    s_add_u32 s95, s95, 75497472
    v_lshlrev_b32 v48, 16, v208
    v_and_b32 v49, s39, v208
    v_lshlrev_b32 v50, 16, v209
    v_and_b32 v51, s39, v209
    v_lshlrev_b32 v52, 16, v210
    v_and_b32 v53, s39, v210
    v_lshlrev_b32 v54, 16, v211
    v_and_b32 v55, s39, v211
    v_pk_mul_f32 v[48:49], v[48:49], v[16:17]
    v_pk_mul_f32 v[50:51], v[50:51], v[18:19]
    v_pk_mul_f32 v[52:53], v[52:53], v[20:21]
    v_pk_mul_f32 v[54:55], v[54:55], v[22:23]
    v_cvt_pk_bf16_f32 v208, v48, v49
    v_cvt_pk_bf16_f32 v209, v50, v51
    v_cvt_pk_bf16_f32 v210, v52, v53
    v_cvt_pk_bf16_f32 v211, v54, v55
    buffer_store_dwordx4 v[208:211], v1, s[20:23], s95 offen offset:0 sc1
    v_lshlrev_b32 v40, 16, v212
    v_and_b32 v41, s39, v212
    v_lshlrev_b32 v42, 16, v213
    v_and_b32 v43, s39, v213
    v_lshlrev_b32 v44, 16, v214
    v_and_b32 v45, s39, v214
    v_lshlrev_b32 v46, 16, v215
    v_and_b32 v47, s39, v215
    v_pk_mul_f32 v[40:41], v[40:41], v[24:25]
    v_pk_mul_f32 v[42:43], v[42:43], v[26:27]
    v_pk_mul_f32 v[44:45], v[44:45], v[28:29]
    v_pk_mul_f32 v[46:47], v[46:47], v[30:31]
    v_cvt_pk_bf16_f32 v212, v40, v41
    v_cvt_pk_bf16_f32 v213, v42, v43
    v_cvt_pk_bf16_f32 v214, v44, v45
    v_cvt_pk_bf16_f32 v215, v46, v47
    buffer_store_dwordx4 v[212:215], v1, s[20:23], s95 offen offset:128 sc1
    v_lshlrev_b32 v48, 16, v216
    v_and_b32 v49, s39, v216
    v_lshlrev_b32 v50, 16, v217
    v_and_b32 v51, s39, v217
    v_lshlrev_b32 v52, 16, v218
    v_and_b32 v53, s39, v218
    v_lshlrev_b32 v54, 16, v219
    v_and_b32 v55, s39, v219
    v_pk_mul_f32 v[48:49], v[48:49], v[32:33]
    v_pk_mul_f32 v[50:51], v[50:51], v[34:35]
    v_pk_mul_f32 v[52:53], v[52:53], v[36:37]
    v_pk_mul_f32 v[54:55], v[54:55], v[38:39]
    v_cvt_pk_bf16_f32 v216, v48, v49
    v_cvt_pk_bf16_f32 v217, v50, v51
    v_cvt_pk_bf16_f32 v218, v52, v53
    v_cvt_pk_bf16_f32 v219, v54, v55
    buffer_store_dwordx4 v[216:219], v1, s[20:23], s95 offen offset:256 sc1
    s_add_u32 s38, s38, 6291456
    v_lshlrev_b32 v40, 16, v136
    v_and_b32 v41, s39, v136
    v_lshlrev_b32 v42, 16, v137
    v_and_b32 v43, s39, v137
    v_lshlrev_b32 v44, 16, v138
    v_and_b32 v45, s39, v138
    v_lshlrev_b32 v46, 16, v139
    v_and_b32 v47, s39, v139
    v_pk_mul_f32 v[40:41], v[40:41], v[16:17]
    v_pk_mul_f32 v[42:43], v[42:43], v[18:19]
    v_pk_mul_f32 v[44:45], v[44:45], v[20:21]
    v_pk_mul_f32 v[46:47], v[46:47], v[22:23]
    v_cvt_pk_bf16_f32 v136, v40, v41
    v_cvt_pk_bf16_f32 v137, v42, v43
    v_cvt_pk_bf16_f32 v138, v44, v45
    v_cvt_pk_bf16_f32 v139, v46, v47
    buffer_store_dwordx4 v[136:139], v1, s[20:23], s38 offen offset:0 sc1
    v_lshlrev_b32 v48, 16, v140
    v_and_b32 v49, s39, v140
    v_lshlrev_b32 v50, 16, v141
    v_and_b32 v51, s39, v141
    v_lshlrev_b32 v52, 16, v142
    v_and_b32 v53, s39, v142
    v_lshlrev_b32 v54, 16, v143
    v_and_b32 v55, s39, v143
    v_pk_mul_f32 v[48:49], v[48:49], v[24:25]
    v_pk_mul_f32 v[50:51], v[50:51], v[26:27]
    v_pk_mul_f32 v[52:53], v[52:53], v[28:29]
    v_pk_mul_f32 v[54:55], v[54:55], v[30:31]
    v_cvt_pk_bf16_f32 v140, v48, v49
    v_cvt_pk_bf16_f32 v141, v50, v51
    v_cvt_pk_bf16_f32 v142, v52, v53
    v_cvt_pk_bf16_f32 v143, v54, v55
    buffer_store_dwordx4 v[140:143], v1, s[20:23], s38 offen offset:128 sc1
    v_lshlrev_b32 v40, 16, v144
    v_and_b32 v41, s39, v144
    v_lshlrev_b32 v42, 16, v145
    v_and_b32 v43, s39, v145
    v_lshlrev_b32 v44, 16, v146
    v_and_b32 v45, s39, v146
    v_lshlrev_b32 v46, 16, v147
    v_and_b32 v47, s39, v147
    v_pk_mul_f32 v[40:41], v[40:41], v[32:33]
    v_pk_mul_f32 v[42:43], v[42:43], v[34:35]
    v_pk_mul_f32 v[44:45], v[44:45], v[36:37]
    v_pk_mul_f32 v[46:47], v[46:47], v[38:39]
    v_cvt_pk_bf16_f32 v144, v40, v41
    v_cvt_pk_bf16_f32 v145, v42, v43
    v_cvt_pk_bf16_f32 v146, v44, v45
    v_cvt_pk_bf16_f32 v147, v46, v47
    buffer_store_dwordx4 v[144:147], v1, s[20:23], s38 offen offset:256 sc1
    s_add_u32 s38, s38, 6291456
    v_lshlrev_b32 v48, 16, v148
    v_and_b32 v49, s39, v148
    v_lshlrev_b32 v50, 16, v149
    v_and_b32 v51, s39, v149
    v_lshlrev_b32 v52, 16, v150
    v_and_b32 v53, s39, v150
    v_lshlrev_b32 v54, 16, v151
    v_and_b32 v55, s39, v151
    v_pk_mul_f32 v[48:49], v[48:49], v[16:17]
    v_pk_mul_f32 v[50:51], v[50:51], v[18:19]
    v_pk_mul_f32 v[52:53], v[52:53], v[20:21]
    v_pk_mul_f32 v[54:55], v[54:55], v[22:23]
    v_cvt_pk_bf16_f32 v148, v48, v49
    v_cvt_pk_bf16_f32 v149, v50, v51
    v_cvt_pk_bf16_f32 v150, v52, v53
    v_cvt_pk_bf16_f32 v151, v54, v55
    buffer_store_dwordx4 v[148:151], v1, s[20:23], s38 offen offset:0 sc1
    v_lshlrev_b32 v40, 16, v152
    v_and_b32 v41, s39, v152
    v_lshlrev_b32 v42, 16, v153
    v_and_b32 v43, s39, v153
    v_lshlrev_b32 v44, 16, v154
    v_and_b32 v45, s39, v154
    v_lshlrev_b32 v46, 16, v155
    v_and_b32 v47, s39, v155
    v_pk_mul_f32 v[40:41], v[40:41], v[24:25]
    v_pk_mul_f32 v[42:43], v[42:43], v[26:27]
    v_pk_mul_f32 v[44:45], v[44:45], v[28:29]
    v_pk_mul_f32 v[46:47], v[46:47], v[30:31]
    v_cvt_pk_bf16_f32 v152, v40, v41
    v_cvt_pk_bf16_f32 v153, v42, v43
    v_cvt_pk_bf16_f32 v154, v44, v45
    v_cvt_pk_bf16_f32 v155, v46, v47
    buffer_store_dwordx4 v[152:155], v1, s[20:23], s38 offen offset:128 sc1
    v_lshlrev_b32 v48, 16, v156
    v_and_b32 v49, s39, v156
    v_lshlrev_b32 v50, 16, v157
    v_and_b32 v51, s39, v157
    v_lshlrev_b32 v52, 16, v158
    v_and_b32 v53, s39, v158
    v_lshlrev_b32 v54, 16, v159
    v_and_b32 v55, s39, v159
    v_pk_mul_f32 v[48:49], v[48:49], v[32:33]
    v_pk_mul_f32 v[50:51], v[50:51], v[34:35]
    v_pk_mul_f32 v[52:53], v[52:53], v[36:37]
    v_pk_mul_f32 v[54:55], v[54:55], v[38:39]
    v_cvt_pk_bf16_f32 v156, v48, v49
    v_cvt_pk_bf16_f32 v157, v50, v51
    v_cvt_pk_bf16_f32 v158, v52, v53
    v_cvt_pk_bf16_f32 v159, v54, v55
    buffer_store_dwordx4 v[156:159], v1, s[20:23], s38 offen offset:256 sc1
    s_add_u32 s38, s38, 6291456
    v_lshlrev_b32 v40, 16, v160
    v_and_b32 v41, s39, v160
    v_lshlrev_b32 v42, 16, v161
    v_and_b32 v43, s39, v161
    v_lshlrev_b32 v44, 16, v162
    v_and_b32 v45, s39, v162
    v_lshlrev_b32 v46, 16, v163
    v_and_b32 v47, s39, v163
    v_pk_mul_f32 v[40:41], v[40:41], v[16:17]
    v_pk_mul_f32 v[42:43], v[42:43], v[18:19]
    v_pk_mul_f32 v[44:45], v[44:45], v[20:21]
    v_pk_mul_f32 v[46:47], v[46:47], v[22:23]
    v_cvt_pk_bf16_f32 v160, v40, v41
    v_cvt_pk_bf16_f32 v161, v42, v43
    v_cvt_pk_bf16_f32 v162, v44, v45
    v_cvt_pk_bf16_f32 v163, v46, v47
    buffer_store_dwordx4 v[160:163], v1, s[20:23], s38 offen offset:0 sc1
    v_lshlrev_b32 v48, 16, v164
    v_and_b32 v49, s39, v164
    v_lshlrev_b32 v50, 16, v165
    v_and_b32 v51, s39, v165
    v_lshlrev_b32 v52, 16, v166
    v_and_b32 v53, s39, v166
    v_lshlrev_b32 v54, 16, v167
    v_and_b32 v55, s39, v167
    v_pk_mul_f32 v[48:49], v[48:49], v[24:25]
    v_pk_mul_f32 v[50:51], v[50:51], v[26:27]
    v_pk_mul_f32 v[52:53], v[52:53], v[28:29]
    v_pk_mul_f32 v[54:55], v[54:55], v[30:31]
    v_cvt_pk_bf16_f32 v164, v48, v49
    v_cvt_pk_bf16_f32 v165, v50, v51
    v_cvt_pk_bf16_f32 v166, v52, v53
    v_cvt_pk_bf16_f32 v167, v54, v55
    buffer_store_dwordx4 v[164:167], v1, s[20:23], s38 offen offset:128 sc1
    v_lshlrev_b32 v40, 16, v168
    v_and_b32 v41, s39, v168
    v_lshlrev_b32 v42, 16, v169
    v_and_b32 v43, s39, v169
    v_lshlrev_b32 v44, 16, v170
    v_and_b32 v45, s39, v170
    v_lshlrev_b32 v46, 16, v171
    v_and_b32 v47, s39, v171
    v_pk_mul_f32 v[40:41], v[40:41], v[32:33]
    v_pk_mul_f32 v[42:43], v[42:43], v[34:35]
    v_pk_mul_f32 v[44:45], v[44:45], v[36:37]
    v_pk_mul_f32 v[46:47], v[46:47], v[38:39]
    v_cvt_pk_bf16_f32 v168, v40, v41
    v_cvt_pk_bf16_f32 v169, v42, v43
    v_cvt_pk_bf16_f32 v170, v44, v45
    v_cvt_pk_bf16_f32 v171, v46, v47
    buffer_store_dwordx4 v[168:171], v1, s[20:23], s38 offen offset:256 sc1
    s_bitcmp1_b64 s[96:97], 42
    s_cselect_b32 s95, s99, s98
    s_add_u32 s95, s95, 88080384
    v_lshlrev_b32 v48, 16, v232
    v_and_b32 v49, s39, v232
    v_lshlrev_b32 v50, 16, v233
    v_and_b32 v51, s39, v233
    v_lshlrev_b32 v52, 16, v234
    v_and_b32 v53, s39, v234
    v_lshlrev_b32 v54, 16, v235
    v_and_b32 v55, s39, v235
    v_pk_mul_f32 v[48:49], v[48:49], v[16:17]
    v_pk_mul_f32 v[50:51], v[50:51], v[18:19]
    v_pk_mul_f32 v[52:53], v[52:53], v[20:21]
    v_pk_mul_f32 v[54:55], v[54:55], v[22:23]
    v_cvt_pk_bf16_f32 v232, v48, v49
    v_cvt_pk_bf16_f32 v233, v50, v51
    v_cvt_pk_bf16_f32 v234, v52, v53
    v_cvt_pk_bf16_f32 v235, v54, v55
    buffer_store_dwordx4 v[232:235], v1, s[20:23], s95 offen offset:0 sc1
    v_lshlrev_b32 v40, 16, v236
    v_and_b32 v41, s39, v236
    v_lshlrev_b32 v42, 16, v237
    v_and_b32 v43, s39, v237
    v_lshlrev_b32 v44, 16, v238
    v_and_b32 v45, s39, v238
    v_lshlrev_b32 v46, 16, v239
    v_and_b32 v47, s39, v239
    v_pk_mul_f32 v[40:41], v[40:41], v[24:25]
    v_pk_mul_f32 v[42:43], v[42:43], v[26:27]
    v_pk_mul_f32 v[44:45], v[44:45], v[28:29]
    v_pk_mul_f32 v[46:47], v[46:47], v[30:31]
    v_cvt_pk_bf16_f32 v236, v40, v41
    v_cvt_pk_bf16_f32 v237, v42, v43
    v_cvt_pk_bf16_f32 v238, v44, v45
    v_cvt_pk_bf16_f32 v239, v46, v47
    buffer_store_dwordx4 v[236:239], v1, s[20:23], s95 offen offset:128 sc1
    v_lshlrev_b32 v48, 16, v240
    v_and_b32 v49, s39, v240
    v_lshlrev_b32 v50, 16, v241
    v_and_b32 v51, s39, v241
    v_lshlrev_b32 v52, 16, v242
    v_and_b32 v53, s39, v242
    v_lshlrev_b32 v54, 16, v243
    v_and_b32 v55, s39, v243
    v_pk_mul_f32 v[48:49], v[48:49], v[32:33]
    v_pk_mul_f32 v[50:51], v[50:51], v[34:35]
    v_pk_mul_f32 v[52:53], v[52:53], v[36:37]
    v_pk_mul_f32 v[54:55], v[54:55], v[38:39]
    v_cvt_pk_bf16_f32 v240, v48, v49
    v_cvt_pk_bf16_f32 v241, v50, v51
    v_cvt_pk_bf16_f32 v242, v52, v53
    v_cvt_pk_bf16_f32 v243, v54, v55
    buffer_store_dwordx4 v[240:243], v1, s[20:23], s95 offen offset:256 sc1
    s_add_u32 s38, s38, 6291456
    v_lshlrev_b32 v40, 16, v172
    v_and_b32 v41, s39, v172
    v_lshlrev_b32 v42, 16, v173
    v_and_b32 v43, s39, v173
    v_lshlrev_b32 v44, 16, v174
    v_and_b32 v45, s39, v174
    v_lshlrev_b32 v46, 16, v175
    v_and_b32 v47, s39, v175
    v_pk_mul_f32 v[40:41], v[40:41], v[16:17]
    v_pk_mul_f32 v[42:43], v[42:43], v[18:19]
    v_pk_mul_f32 v[44:45], v[44:45], v[20:21]
    v_pk_mul_f32 v[46:47], v[46:47], v[22:23]
    v_cvt_pk_bf16_f32 v172, v40, v41
    v_cvt_pk_bf16_f32 v173, v42, v43
    v_cvt_pk_bf16_f32 v174, v44, v45
    v_cvt_pk_bf16_f32 v175, v46, v47
    buffer_store_dwordx4 v[172:175], v1, s[20:23], s38 offen offset:0 sc1
    v_lshlrev_b32 v48, 16, v176
    v_and_b32 v49, s39, v176
    v_lshlrev_b32 v50, 16, v177
    v_and_b32 v51, s39, v177
    v_lshlrev_b32 v52, 16, v178
    v_and_b32 v53, s39, v178
    v_lshlrev_b32 v54, 16, v179
    v_and_b32 v55, s39, v179
    v_pk_mul_f32 v[48:49], v[48:49], v[24:25]
    v_pk_mul_f32 v[50:51], v[50:51], v[26:27]
    v_pk_mul_f32 v[52:53], v[52:53], v[28:29]
    v_pk_mul_f32 v[54:55], v[54:55], v[30:31]
    v_cvt_pk_bf16_f32 v176, v48, v49
    v_cvt_pk_bf16_f32 v177, v50, v51
    v_cvt_pk_bf16_f32 v178, v52, v53
    v_cvt_pk_bf16_f32 v179, v54, v55
    buffer_store_dwordx4 v[176:179], v1, s[20:23], s38 offen offset:128 sc1
    v_lshlrev_b32 v40, 16, v180
    v_and_b32 v41, s39, v180
    v_lshlrev_b32 v42, 16, v181
    v_and_b32 v43, s39, v181
    v_lshlrev_b32 v44, 16, v182
    v_and_b32 v45, s39, v182
    v_lshlrev_b32 v46, 16, v183
    v_and_b32 v47, s39, v183
    v_pk_mul_f32 v[40:41], v[40:41], v[32:33]
    v_pk_mul_f32 v[42:43], v[42:43], v[34:35]
    v_pk_mul_f32 v[44:45], v[44:45], v[36:37]
    v_pk_mul_f32 v[46:47], v[46:47], v[38:39]
    v_cvt_pk_bf16_f32 v180, v40, v41
    v_cvt_pk_bf16_f32 v181, v42, v43
    v_cvt_pk_bf16_f32 v182, v44, v45
    v_cvt_pk_bf16_f32 v183, v46, v47
    buffer_store_dwordx4 v[180:183], v1, s[20:23], s38 offen offset:256 sc1
    s_add_u32 s38, s38, 6291456
    v_lshlrev_b32 v48, 16, v184
    v_and_b32 v49, s39, v184
    v_lshlrev_b32 v50, 16, v185
    v_and_b32 v51, s39, v185
    v_lshlrev_b32 v52, 16, v186
    v_and_b32 v53, s39, v186
    v_lshlrev_b32 v54, 16, v187
    v_and_b32 v55, s39, v187
    v_pk_mul_f32 v[48:49], v[48:49], v[16:17]
    v_pk_mul_f32 v[50:51], v[50:51], v[18:19]
    v_pk_mul_f32 v[52:53], v[52:53], v[20:21]
    v_pk_mul_f32 v[54:55], v[54:55], v[22:23]
    v_cvt_pk_bf16_f32 v184, v48, v49
    v_cvt_pk_bf16_f32 v185, v50, v51
    v_cvt_pk_bf16_f32 v186, v52, v53
    v_cvt_pk_bf16_f32 v187, v54, v55
    buffer_store_dwordx4 v[184:187], v1, s[20:23], s38 offen offset:0 sc1
    v_lshlrev_b32 v40, 16, v188
    v_and_b32 v41, s39, v188
    v_lshlrev_b32 v42, 16, v189
    v_and_b32 v43, s39, v189
    v_lshlrev_b32 v44, 16, v190
    v_and_b32 v45, s39, v190
    v_lshlrev_b32 v46, 16, v191
    v_and_b32 v47, s39, v191
    v_pk_mul_f32 v[40:41], v[40:41], v[24:25]
    v_pk_mul_f32 v[42:43], v[42:43], v[26:27]
    v_pk_mul_f32 v[44:45], v[44:45], v[28:29]
    v_pk_mul_f32 v[46:47], v[46:47], v[30:31]
    v_cvt_pk_bf16_f32 v188, v40, v41
    v_cvt_pk_bf16_f32 v189, v42, v43
    v_cvt_pk_bf16_f32 v190, v44, v45
    v_cvt_pk_bf16_f32 v191, v46, v47
    buffer_store_dwordx4 v[188:191], v1, s[20:23], s38 offen offset:128 sc1
    v_lshlrev_b32 v48, 16, v192
    v_and_b32 v49, s39, v192
    v_lshlrev_b32 v50, 16, v193
    v_and_b32 v51, s39, v193
    v_lshlrev_b32 v52, 16, v194
    v_and_b32 v53, s39, v194
    v_lshlrev_b32 v54, 16, v195
    v_and_b32 v55, s39, v195
    v_pk_mul_f32 v[48:49], v[48:49], v[32:33]
    v_pk_mul_f32 v[50:51], v[50:51], v[34:35]
    v_pk_mul_f32 v[52:53], v[52:53], v[36:37]
    v_pk_mul_f32 v[54:55], v[54:55], v[38:39]
    v_cvt_pk_bf16_f32 v192, v48, v49
    v_cvt_pk_bf16_f32 v193, v50, v51
    v_cvt_pk_bf16_f32 v194, v52, v53
    v_cvt_pk_bf16_f32 v195, v54, v55
    buffer_store_dwordx4 v[192:195], v1, s[20:23], s38 offen offset:256 sc1
    s_add_u32 s38, s38, 18874368
    v_lshlrev_b32 v40, 16, v220
    v_and_b32 v41, s39, v220
    v_lshlrev_b32 v42, 16, v221
    v_and_b32 v43, s39, v221
    v_lshlrev_b32 v44, 16, v222
    v_and_b32 v45, s39, v222
    v_lshlrev_b32 v46, 16, v223
    v_and_b32 v47, s39, v223
    v_pk_mul_f32 v[40:41], v[40:41], v[16:17]
    v_pk_mul_f32 v[42:43], v[42:43], v[18:19]
    v_pk_mul_f32 v[44:45], v[44:45], v[20:21]
    v_pk_mul_f32 v[46:47], v[46:47], v[22:23]
    v_cvt_pk_bf16_f32 v220, v40, v41
    v_cvt_pk_bf16_f32 v221, v42, v43
    v_cvt_pk_bf16_f32 v222, v44, v45
    v_cvt_pk_bf16_f32 v223, v46, v47
    buffer_store_dwordx4 v[220:223], v1, s[20:23], s38 offen offset:0 sc1
    v_lshlrev_b32 v48, 16, v224
    v_and_b32 v49, s39, v224
    v_lshlrev_b32 v50, 16, v225
    v_and_b32 v51, s39, v225
    v_lshlrev_b32 v52, 16, v226
    v_and_b32 v53, s39, v226
    v_lshlrev_b32 v54, 16, v227
    v_and_b32 v55, s39, v227
    v_pk_mul_f32 v[48:49], v[48:49], v[24:25]
    v_pk_mul_f32 v[50:51], v[50:51], v[26:27]
    v_pk_mul_f32 v[52:53], v[52:53], v[28:29]
    v_pk_mul_f32 v[54:55], v[54:55], v[30:31]
    v_cvt_pk_bf16_f32 v224, v48, v49
    v_cvt_pk_bf16_f32 v225, v50, v51
    v_cvt_pk_bf16_f32 v226, v52, v53
    v_cvt_pk_bf16_f32 v227, v54, v55
    buffer_store_dwordx4 v[224:227], v1, s[20:23], s38 offen offset:128 sc1
    v_lshlrev_b32 v40, 16, v228
    v_and_b32 v41, s39, v228
    v_lshlrev_b32 v42, 16, v229
    v_and_b32 v43, s39, v229
    v_lshlrev_b32 v44, 16, v230
    v_and_b32 v45, s39, v230
    v_lshlrev_b32 v46, 16, v231
    v_and_b32 v47, s39, v231
    v_pk_mul_f32 v[40:41], v[40:41], v[32:33]
    v_pk_mul_f32 v[42:43], v[42:43], v[34:35]
    v_pk_mul_f32 v[44:45], v[44:45], v[36:37]
    v_pk_mul_f32 v[46:47], v[46:47], v[38:39]
    v_cvt_pk_bf16_f32 v228, v40, v41
    v_cvt_pk_bf16_f32 v229, v42, v43
    v_cvt_pk_bf16_f32 v230, v44, v45
    v_cvt_pk_bf16_f32 v231, v46, v47
    buffer_store_dwordx4 v[228:231], v1, s[20:23], s100 offen offset:256 sc1
    v_lshlrev_b32 v48, 16, v4
    v_and_b32 v49, s39, v4
    v_lshlrev_b32 v50, 16, v5
    v_and_b32 v51, s39, v5
    v_lshlrev_b32 v52, 16, v6
    v_and_b32 v53, s39, v6
    v_lshlrev_b32 v54, 16, v7
    v_and_b32 v55, s39, v7
    v_pk_mul_f32 v[48:49], v[48:49], v[32:33]
    v_pk_mul_f32 v[50:51], v[50:51], v[34:35]
    v_pk_mul_f32 v[52:53], v[52:53], v[36:37]
    v_pk_mul_f32 v[54:55], v[54:55], v[38:39]
    v_cvt_pk_bf16_f32 v4, v48, v49
    v_cvt_pk_bf16_f32 v5, v50, v51
    v_cvt_pk_bf16_f32 v6, v52, v53
    v_cvt_pk_bf16_f32 v7, v54, v55
    buffer_store_dwordx4 v[4:7], v1, s[20:23], s101 offen offset:256 sc1
    s_bitcmp1_b64 s[96:97], 45
    s_cselect_b32 s95, s99, s98
    s_add_u32 s95, s95, 94371840
    v_lshlrev_b32 v40, 16, v244
    v_and_b32 v41, s39, v244
    v_lshlrev_b32 v42, 16, v245
    v_and_b32 v43, s39, v245
    v_lshlrev_b32 v44, 16, v246
    v_and_b32 v45, s39, v246
    v_lshlrev_b32 v46, 16, v247
    v_and_b32 v47, s39, v247
    v_pk_mul_f32 v[40:41], v[40:41], v[16:17]
    v_pk_mul_f32 v[42:43], v[42:43], v[18:19]
    v_pk_mul_f32 v[44:45], v[44:45], v[20:21]
    v_pk_mul_f32 v[46:47], v[46:47], v[22:23]
    v_cvt_pk_bf16_f32 v244, v40, v41
    v_cvt_pk_bf16_f32 v245, v42, v43
    v_cvt_pk_bf16_f32 v246, v44, v45
    v_cvt_pk_bf16_f32 v247, v46, v47
    buffer_store_dwordx4 v[244:247], v1, s[20:23], s95 offen offset:0 sc1
    v_lshlrev_b32 v48, 16, v248
    v_and_b32 v49, s39, v248
    v_lshlrev_b32 v50, 16, v249
    v_and_b32 v51, s39, v249
    v_lshlrev_b32 v52, 16, v250
    v_and_b32 v53, s39, v250
    v_lshlrev_b32 v54, 16, v251
    v_and_b32 v55, s39, v251
    v_pk_mul_f32 v[48:49], v[48:49], v[24:25]
    v_pk_mul_f32 v[50:51], v[50:51], v[26:27]
    v_pk_mul_f32 v[52:53], v[52:53], v[28:29]
    v_pk_mul_f32 v[54:55], v[54:55], v[30:31]
    v_cvt_pk_bf16_f32 v248, v48, v49
    v_cvt_pk_bf16_f32 v249, v50, v51
    v_cvt_pk_bf16_f32 v250, v52, v53
    v_cvt_pk_bf16_f32 v251, v54, v55
    buffer_store_dwordx4 v[248:251], v1, s[20:23], s95 offen offset:128 sc1
    v_lshlrev_b32 v40, 16, v252
    v_and_b32 v41, s39, v252
    v_lshlrev_b32 v42, 16, v253
    v_and_b32 v43, s39, v253
    v_lshlrev_b32 v44, 16, v254
    v_and_b32 v45, s39, v254
    v_lshlrev_b32 v46, 16, v255
    v_and_b32 v47, s39, v255
    v_pk_mul_f32 v[40:41], v[40:41], v[32:33]
    v_pk_mul_f32 v[42:43], v[42:43], v[34:35]
    v_pk_mul_f32 v[44:45], v[44:45], v[36:37]
    v_pk_mul_f32 v[46:47], v[46:47], v[38:39]
    v_cvt_pk_bf16_f32 v252, v40, v41
    v_cvt_pk_bf16_f32 v253, v42, v43
    v_cvt_pk_bf16_f32 v254, v44, v45
    v_cvt_pk_bf16_f32 v255, v46, v47
    buffer_store_dwordx4 v[252:255], v1, s[20:23], s95 offen offset:256 sc1
L_end:
    s_endpgm
L_others:
    s_waitcnt lgkmcnt(0)
    s_barrier
    s_branch L_wait_s
L_poll_again:
    s_sleep 1
    s_sub_u32 s50, s50, 1
    s_cmp_lg_u32 s50, 0
    s_cbranch_scc1 L_poll
L_giveup:
    v_mov_b32 v36, -2.0
    v_lshlrev_b32 v35, 2, v3
    s_branch L_mark
L_mismatch:
    s_cmp_eq_u32 s94, 1
    s_cbranch_scc1 L_mlp
    v_mov_b32 v36, -1.0
L_mark:
    ds_write_b32 v35, v36 offset:20992
    s_waitcnt lgkmcnt(0)
    s_branch L_wait_s
L_restart:
    s_waitcnt lgkmcnt(0)
    v_cmp_gt_f32 vcc, -1.0, v16
    s_cbranch_vccnz L_solo
    s_mov_b32 s94, 1
    buffer_load_dwordx4 v[64:67], v1, s[16:19], s56 offen offset:0 nt
    buffer_load_dwordx4 v[68:71], v1, s[16:19], s56 offen offset:128 nt
    buffer_load_dwordx4 v[72:75], v1, s[16:19], s56 offen offset:256 nt
    s_branch L_loads2
L_special:
    s_lshr_b32 s48, s2, 6
    s_cmp_lg_u32 s48, 1
    s_cbranch_scc1 L_voter
    s_cmp_lg_u32 s2, 64
    s_cbranch_scc1 L_w
    s_load_dwordx2 s[24:25], s[0:1], 8
    s_load_dwordx2 s[28:29], s[0:1], 16
    s_load_dwordx2 s[20:21], s[0:1], 24
    s_load_dwordx2 s[32:33], s[0:1], 32
    s_load_dwordx2 s[40:41], s[0:1], 40
    v_and_b32 v3, 63, v0
    v_lshlrev_b32 v4, 4, v0
    v_lshlrev_b32 v9, 4, v3
    s_mov_b32 s22, 100663296
    s_mov_b32 s23, 0x20000
    s_mov_b32 s34, 256
    s_mov_b32 s35, 0x20000
    s_mov_b32 s42, 402653184
    s_mov_b32 s43, 0x20000
    s_getreg_b32 s59, hwreg(HW_REG_XCC_ID)
    s_bfe_u32 s57, s59, 0x10002
    v_mov_b32 v16, -1
    v_mov_b32 v17, -1
    v_mov_b32 v18, -1
    v_mov_b32 v19, -1
    s_lshl_b32 s45, s36, 12
    s_add_u32 s45, s45, 1048576
    s_waitcnt lgkmcnt(0)
    buffer_store_dwordx4 v[16:19], v9, s[40:43], s45 offen offset:0 sc1
    buffer_store_dwordx4 v[16:19], v9, s[40:43], s45 offen offset:1024 sc1
    buffer_store_dwordx4 v[16:19], v9, s[40:43], s45 offen offset:2048 sc1
    buffer_store_dwordx4 v[16:19], v9, s[40:43], s45 offen offset:3072 sc1
    s_branch L_loads
L_flag:
    v_mov_b32 v16, 2
    s_mov_b64 exec, 1
    buffer_store_dword v16, v13, s[32:35], 0 offen offset:252 sc1
    s_mov_b64 exec, -1
    s_branch L_flag_back
L_voter:
    s_cmp_eq_u32 s36, 0
    s_cbranch_scc1 L_probe
    s_barrier
    s_branch L_w
L_probe:
    s_load_dwordx2 s[24:25], s[0:1], 8
    s_load_dwordx2 s[28:29], s[0:1], 16
    s_load_dwordx2 s[20:21], s[0:1], 24
    s_load_dwordx2 s[32:33], s[0:1], 32
    s_load_dwordx2 s[40:41], s[0:1], 40
    v_and_b32 v3, 63, v0
    v_lshlrev_b32 v4, 4, v0
    v_lshlrev_b32 v9, 4, v3
    s_mov_b32 s22, 100663296
    s_mov_b32 s23, 0x20000
    s_mov_b32 s34, 256
    s_mov_b32 s35, 0x20000
    s_mov_b32 s42, 402653184
    s_mov_b32 s43, 0x20000
    s_getreg_b32 s59, hwreg(HW_REG_XCC_ID)
    s_bfe_u32 s57, s59, 0x10002
    s_max_u32 s48, s48, 1
    s_sub_u32 s48, s48, 1
    s_bfe_u32 s49, s2, 0x20001
    s_mul_i32 s55, s49, 3
    s_add_u32 s55, s55, s48
    s_lshl_b32 s55, s55, 2
    v_mov_b32 v17, s55
    s_lshl_b32 s49, s49, 3
    s_lshr_b32 s50, 0xf0e0c0b, s49
    s_and_b32 s50, s50, 15
    s_add_u32 s49, s50, s48
    s_and_b32 s47, s49, 1
    s_mul_i32 s50, s50, 6291456
    s_add_u32 s50, s50, s56
    s_add_u32 s50, s50, 1536
    s_mov_b64 exec, 0xff
    s_waitcnt lgkmcnt(0)
    s_add_u32 s51, s20, 1536
    s_lshr_b32 s51, s51, 10
    s_or_b32 s51, s51, 1
    s_sub_u32 s51, 3, s51
    s_lshl3_add_u32 s51, s47, s51
    s_mul_i32 s51, s51, 11
    s_and_b32 s51, s51, 15
    s_xor_b32 s52, s51, 8
    s_mulk_i32 s51, 3072
    s_mulk_i32 s52, 3072
    s_add_u32 s51, s51, s50
    s_add_u32 s52, s52, s50
    s_branch L_timed
.p2align 6
L_timed:
    s_barrier
    buffer_store_dwordx4 v[4:7], v9, s[20:23], s51 offen sc1
    buffer_store_dwordx4 v[4:7], v9, s[20:23], s52 offen sc1
    s_waitcnt vmcnt(1)
    s_memtime s[52:53]
    s_waitcnt vmcnt(0)
    s_memtime s[50:51]
    s_mov_b64 exec, 1
    s_waitcnt lgkmcnt(0)
    s_sub_u32 s54, s50, s52
    s_cmp_gt_u32 s54, 100
    s_cselect_b32 s54, 2, 3
    s_xor_b32 s54, s54, s57
    v_mov_b32 v16, s54
    buffer_store_dword v16, v17, s[32:35], 0 offen sc1
    s_mov_b64 exec, -1
    s_branch L_loads
L_notready:
    s_mov_b32 s50, 4000
L_readyspin:
    buffer_load_dword v14, v13, s[32:35], 0 offen offset:252 sc1
    s_waitcnt vmcnt(0)
    v_cmp_eq_u32 vcc, 0, v14
    s_cbranch_vccz L_ready
    s_sleep 2
    s_sub_u32 s50, s50, 1
    s_cmp_lg_u32 s50, 0
    s_cbranch_scc1 L_readyspin
    s_waitcnt lgkmcnt(0)
    s_barrier
    s_branch L_giveup
L_votes_slow:
    s_mov_b32 s50, 4000
    v_lshlrev_b32 v15, 2, v3
L_votes_spin:
    buffer_load_dword v14, v15, s[32:35], 0 offen sc1
    s_waitcnt vmcnt(0)
    v_readlane_b32 s76, v14, 0
    v_readlane_b32 s77, v14, 1
    v_readlane_b32 s78, v14, 2
    v_readlane_b32 s79, v14, 3
    v_readlane_b32 s80, v14, 4
    v_readlane_b32 s81, v14, 5
    v_readlane_b32 s82, v14, 6
    v_readlane_b32 s83, v14, 7
    v_readlane_b32 s84, v14, 8
    v_readlane_b32 s85, v14, 9
    v_readlane_b32 s86, v14, 10
    v_readlane_b32 s87, v14, 11
    s_and_b32 s45, s76, s77
    s_and_b32 s45, s45, s78
    s_and_b32 s45, s45, s79
    s_and_b32 s45, s45, s80
    s_and_b32 s45, s45, s81
    s_and_b32 s45, s45, s82
    s_and_b32 s45, s45, s83
    s_and_b32 s45, s45, s84
    s_and_b32 s45, s45, s85
    s_and_b32 s45, s45, s86
    s_and_b32 s45, s45, s87
    s_bitcmp1_b32 s45, 1
    s_cbranch_scc1 L_votes_ok
    s_sleep 2
    s_sub_u32 s50, s50, 1
    s_cmp_lg_u32 s50, 0
    s_cbranch_scc1 L_votes_spin
L_votes_giveup:
    v_mov_b32 v14, 8
    ds_write_b32 v13, v14 offset:22016
    s_branch L_votes_ok
L_solo:
    ds_read_b128 v[16:19], v9 offset:9216
    ds_read_b128 v[20:23], v9 offset:10240
    ds_read_b128 v[24:27], v9 offset:11264
    ds_read_b128 v[28:31], v9 offset:12288
    ds_read_b128 v[32:35], v9 offset:13312
    ds_read_b128 v[36:39], v9 offset:14336
    ds_read_b128 v[40:43], v9 offset:15360
    ds_read_b128 v[44:47], v9 offset:16384
    ds_read_b128 v[48:51], v9 offset:17408
    v_mov_b32 v52, 0
    v_mov_b32 v53, 0
    v_mov_b32 v54, 0
    v_mov_b32 v55, 0
    v_mov_b32 v56, 0
    v_mov_b32 v57, 0
    v_mov_b32 v58, 0
    v_mov_b32 v59, 0
    v_mov_b32 v60, 0
    v_mov_b32 v61, 0
    v_mov_b32 v62, 0
    v_mov_b32 v63, 0
    s_mul_i32 s37, s36, 3072
    s_waitcnt lgkmcnt(0)
L_solo_sum:
    buffer_load_dwordx4 v[64:67], v1, s[16:19], s37 offen offset:0
    buffer_load_dwordx4 v[68:71], v1, s[16:19], s37 offen offset:128
    buffer_load_dwordx4 v[72:75], v1, s[16:19], s37 offen offset:256
    s_add_u32 s37, s37, 24576
    buffer_load_dwordx4 v[76:79], v1, s[16:19], s37 offen offset:0
    buffer_load_dwordx4 v[80:83], v1, s[16:19], s37 offen offset:128
    buffer_load_dwordx4 v[84:87], v1, s[16:19], s37 offen offset:256
    s_add_u32 s37, s37, 24576
    s_waitcnt vmcnt(0)
    v_mfma_f32_16x16x32_bf16 v[52:55], v[64:67], v[16:19], v[52:55]
    v_mfma_f32_16x16x32_bf16 v[56:59], v[64:67], v[20:23], v[56:59]
    v_mfma_f32_16x16x32_bf16 v[60:63], v[64:67], v[24:27], v[60:63]
    v_mfma_f32_16x16x32_bf16 v[52:55], v[68:71], v[28:31], v[52:55]
    v_mfma_f32_16x16x32_bf16 v[56:59], v[68:71], v[32:35], v[56:59]
    v_mfma_f32_16x16x32_bf16 v[60:63], v[68:71], v[36:39], v[60:63]
    v_mfma_f32_16x16x32_bf16 v[52:55], v[72:75], v[40:43], v[52:55]
    v_mfma_f32_16x16x32_bf16 v[56:59], v[72:75], v[44:47], v[56:59]
    v_mfma_f32_16x16x32_bf16 v[60:63], v[72:75], v[48:51], v[60:63]
    v_mfma_f32_16x16x32_bf16 v[52:55], v[76:79], v[16:19], v[52:55]
    v_mfma_f32_16x16x32_bf16 v[56:59], v[76:79], v[20:23], v[56:59]
    v_mfma_f32_16x16x32_bf16 v[60:63], v[76:79], v[24:27], v[60:63]
    v_mfma_f32_16x16x32_bf16 v[52:55], v[80:83], v[28:31], v[52:55]
    v_mfma_f32_16x16x32_bf16 v[56:59], v[80:83], v[32:35], v[56:59]
    v_mfma_f32_16x16x32_bf16 v[60:63], v[80:83], v[36:39], v[60:63]
    v_mfma_f32_16x16x32_bf16 v[52:55], v[84:87], v[40:43], v[52:55]
    v_mfma_f32_16x16x32_bf16 v[56:59], v[84:87], v[44:47], v[56:59]
    v_mfma_f32_16x16x32_bf16 v[60:63], v[84:87], v[48:51], v[60:63]
    s_cmp_lt_u32 s37, s18
    s_cbranch_scc1 L_solo_sum
    s_nop 7
    v_add_f32_dpp v52, v53, v52 row_shl:4 row_mask:0xf bank_mask:0xf
    v_add_f32_dpp v56, v57, v56 row_shl:4 row_mask:0xf bank_mask:0xf
    v_add_f32_dpp v60, v61, v60 row_shl:4 row_mask:0xf bank_mask:0xf
    v_add_f32_dpp v52, v54, v52 row_shl:8 row_mask:0xf bank_mask:0xf
    v_add_f32_dpp v56, v58, v56 row_shl:8 row_mask:0xf bank_mask:0xf
    v_add_f32_dpp v60, v62, v60 row_shl:8 row_mask:0xf bank_mask:0xf
    v_add_f32_dpp v52, v55, v52 row_shl:12 row_mask:0xf bank_mask:0xf
    v_add_f32_dpp v56, v59, v56 row_shl:12 row_mask:0xf bank_mask:0xf
    v_add_f32_dpp v60, v63, v60 row_shl:12 row_mask:0xf bank_mask:0xf
    s_mov_b32 exec_lo, 0x000f000f
    s_mov_b32 exec_hi, 0x000f000f
    ds_write_b32 v11, v52 offset:18432
    ds_write_b32 v11, v56 offset:19008
    ds_write_b32 v11, v60 offset:19584
    s_mov_b64 exec, -1
    v_lshrrev_b32 v14, 4, v3
    v_bfe_u32 v13, v3, 2, 2
    v_mad_u32_u24 v12, v14, 3, v13
    v_mul_u32_u24 v12, 144, v12
    v_and_b32 v13, 3, v3
    v_lshl_add_u32 v12, v13, 5, v12
    s_waitcnt lgkmcnt(0)
    s_barrier
    s_cmp_lg_u32 s36, 7
    s_cbranch_scc1 L_solo_s
    ds_read_b128 v[16:19], v12 offset:18432
    ds_read_b128 v[20:23], v12 offset:18448
    s_waitcnt lgkmcnt(0)
    v_pk_add_f32 v[16:17], v[16:17], v[18:19]
    v_pk_add_f32 v[20:21], v[20:21], v[22:23]
    v_pk_add_f32 v[16:17], v[16:17], v[20:21]
    v_add_f32 v16, v16, v17
    s_nop 1
    v_add_f32_dpp v16, v16, v16 quad_perm:[1,0,3,2] row_mask:0xf bank_mask:0xf
    s_nop 1
    v_add_f32_dpp v16, v16, v16 quad_perm:[2,3,0,1] row_mask:0xf bank_mask:0xf
    ds_write_b32 v8, v16 offset:22080
    v_lshlrev_b32 v15, 1, v3
    ds_read_u16 v34, v15 offset:4608
    ds_read_u16 v35, v15 offset:4992
    ds_read_u16 v36, v15 offset:5376
    ds_read_u16 v37, v15 offset:5760
    ds_read_u16 v38, v15 offset:6144
    ds_read_u16 v39, v15 offset:6528
    ds_read_u16 v40, v15 offset:6912
    ds_read_u16 v41, v15 offset:7296
    ds_read_u16 v42, v15 offset:7680
    ds_read_u16 v43, v15 offset:8064
    ds_read_u16 v44, v15 offset:8448
    ds_read_u16 v45, v15 offset:8832
    s_waitcnt lgkmcnt(0)
    v_lshl_or_b32 v16, v35, 16, v34
    v_lshl_or_b32 v17, v38, 16, v37
    v_lshl_or_b32 v18, v41, 16, v40
    v_lshl_or_b32 v19, v44, 16, v43
    v_lshl_or_b32 v20, v39, 16, v36
    v_lshl_or_b32 v21, v45, 16, v42
    ds_read_u16 v34, v15 offset:4736
    ds_read_u16 v35, v15 offset:5120
    ds_read_u16 v36, v15 offset:5504
    ds_read_u16 v37, v15 offset:5888
    ds_read_u16 v38, v15 offset:6272
    ds_read_u16 v39, v15 offset:6656
    ds_read_u16 v40, v15 offset:7040
    ds_read_u16 v41, v15 offset:7424
    ds_read_u16 v42, v15 offset:7808
    ds_read_u16 v43, v15 offset:8192
    ds_read_u16 v44, v15 offset:8576
    ds_read_u16 v45, v15 offset:8960
    s_waitcnt lgkmcnt(0)
    v_lshl_or_b32 v22, v35, 16, v34
    v_lshl_or_b32 v23, v38, 16, v37
    v_lshl_or_b32 v24, v41, 16, v40
    v_lshl_or_b32 v25, v44, 16, v43
    v_lshl_or_b32 v26, v39, 16, v36
    v_lshl_or_b32 v27, v45, 16, v42
    ds_read_u16 v34, v15 offset:4864
    ds_read_u16 v35, v15 offset:5248
    ds_read_u16 v36, v15 offset:5632
    ds_read_u16 v37, v15 offset:6016
    ds_read_u16 v38, v15 offset:6400
    ds_read_u16 v39, v15 offset:6784
    ds_read_u16 v40, v15 offset:7168
    ds_read_u16 v41, v15 offset:7552
    ds_read_u16 v42, v15 offset:7936
    ds_read_u16 v43, v15 offset:8320
    ds_read_u16 v44, v15 offset:8704
    ds_read_u16 v45, v15 offset:9088
    s_waitcnt lgkmcnt(0)
    v_lshl_or_b32 v28, v35, 16, v34
    v_lshl_or_b32 v29, v38, 16, v37
    v_lshl_or_b32 v30, v41, 16, v40
    v_lshl_or_b32 v31, v44, 16, v43
    v_lshl_or_b32 v32, v39, 16, v36
    v_lshl_or_b32 v33, v45, 16, v42
    s_mov_b32 s12, 0x0f000f00
    s_mov_b32 s13, 0x0f000f00
    s_mov_b32 s14, 0x00f000f0
    s_mov_b32 s15, 0x00f000f0
    s_mov_b32 s46, 0x36800000
    s_mov_b32 s47, 0xbfb8aa3b
    v_lshlrev_b32 v35, 2, v3
    v_mov_b32 v12, 0
    v_mov_b32 v13, 0
    v_mov_b32 v14, 0
    v_mov_b32 v15, 0
    s_mov_b64 exec, 15
    ds_read_b128 v[12:15], v9 offset:22080
    s_mov_b64 exec, -1
    s_waitcnt lgkmcnt(0)
    v_add_f32_dpp v12, v12, v12 row_ror:8 row_mask:0xf bank_mask:0xf
    v_add_f32_dpp v13, v13, v13 row_ror:8 row_mask:0xf bank_mask:0xf
    v_add_f32_dpp v14, v14, v14 row_ror:8 row_mask:0xf bank_mask:0xf
    v_add_f32_dpp v12, v12, v12 row_ror:4 row_mask:0xf bank_mask:0xf
    v_add_f32_dpp v13, v13, v13 row_ror:4 row_mask:0xf bank_mask:0xf
    v_add_f32_dpp v14, v14, v14 row_ror:4 row_mask:0xf bank_mask:0xf
    v_cndmask_b32 v12, v12, v13, s[14:15]
    v_cndmask_b32 v12, v12, v14, s[12:13]
    v_mov_b32 v36, v12
    s_nop 1
    v_permlane32_swap_b32 v12, v36
    s_nop 0
    v_add_f32 v12, v12, v36
    v_mov_b32 v36, v12
    s_nop 1
    v_permlane16_swap_b32 v12, v36
    s_nop 0
    v_add_f32 v12, v12, v36
    v_mul_f32 v12, s46, v12
    v_cvt_pk_bf16_f32 v12, v12, v12
    v_and_b32 v12, s39, v12
    v_mul_f32 v36, s47, v12
    v_exp_f32 v36, v36
    s_nop 0
    v_add_f32 v36, 1.0, v36
    v_rcp_f32 v36, v36
    s_nop 0
    v_mul_f32 v12, v12, v36
    s_nop 1
    v_mov_b32_dpp v36, v12 row_shl:4 row_mask:0xf bank_mask:0xf
    v_mov_b32_dpp v37, v12 quad_perm:[1,1,3,3] row_mask:0xf bank_mask:0xf
    v_cvt_pk_bf16_f32 v36, v12, v36
    v_cvt_pk_bf16_f32 v37, v12, v37
    v_readlane_b32 s76, v36, 0
    v_readlane_b32 s77, v36, 1
    v_readlane_b32 s78, v36, 2
    v_readlane_b32 s79, v36, 3
    v_readlane_b32 s80, v37, 8
    v_readlane_b32 s81, v37, 10
    v_dot2_f32_bf16 v36, s76, v16, 0
    v_dot2_f32_bf16 v37, s76, v22, 0
    v_dot2_f32_bf16 v38, s76, v28, 0
    v_dot2_f32_bf16 v36, s77, v17, v36
    v_dot2_f32_bf16 v37, s77, v23, v37
    v_dot2_f32_bf16 v38, s77, v29, v38
    v_dot2_f32_bf16 v36, s78, v18, v36
    v_dot2_f32_bf16 v37, s78, v24, v37
    v_dot2_f32_bf16 v38, s78, v30, v38
    v_dot2_f32_bf16 v36, s79, v19, v36
    v_dot2_f32_bf16 v37, s79, v25, v37
    v_dot2_f32_bf16 v38, s79, v31, v38
    v_dot2_f32_bf16 v36, s80, v20, v36
    v_dot2_f32_bf16 v37, s80, v26, v37
    v_dot2_f32_bf16 v38, s80, v32, v38
    v_dot2_f32_bf16 v36, s81, v21, v36
    v_dot2_f32_bf16 v37, s81, v27, v37
    v_dot2_f32_bf16 v38, s81, v33, v38
    s_nop 1
    v_cvt_pk_bf16_f32 v36, v36, v36
    v_cvt_pk_bf16_f32 v37, v37, v37
    v_cvt_pk_bf16_f32 v38, v38, v38
    v_and_b32 v36, s39, v36
    v_and_b32 v37, s39, v37
    v_and_b32 v38, s39, v38
    v_mul_f32 v36, s47, v36
    v_mul_f32 v37, s47, v37
    v_mul_f32 v38, s47, v38
    v_exp_f32 v36, v36
    v_exp_f32 v37, v37
    v_exp_f32 v38, v38
    s_nop 0
    v_add_f32 v36, 1.0, v36
    v_add_f32 v37, 1.0, v37
    v_add_f32 v38, 1.0, v38
    v_rcp_f32 v36, v36
    v_rcp_f32 v37, v37
    v_rcp_f32 v38, v38
    s_nop 0
    v_cvt_pk_bf16_f32 v36, v36, v36
    v_cvt_pk_bf16_f32 v37, v37, v37
    v_cvt_pk_bf16_f32 v38, v38, v38
    v_and_b32 v36, s39, v36
    v_and_b32 v37, s39, v37
    v_and_b32 v38, s39, v38
    ds_write_b32 v35, v36 offset:20992
    ds_write_b32 v35, v37 offset:21248
    ds_write_b32 v35, v38 offset:21504
    s_waitcnt lgkmcnt(0)
L_solo_s:
    s_barrier
    ds_read_b128 v[16:19], v10 offset:20992
    ds_read_b128 v[20:23], v10 offset:21008
    ds_read_b128 v[24:27], v10 offset:21248
    ds_read_b128 v[28:31], v10 offset:21264
    ds_read_b128 v[32:35], v10 offset:21504
    ds_read_b128 v[36:39], v10 offset:21520
    s_mov_b32 s45, 0
    s_waitcnt lgkmcnt(0)
L_solo_out:
    s_lshr_b32 s46, s2, 1
    s_bitcmp1_b32 s45, 1
    s_cselect_b32 s46, s58, s46
    s_lshl3_add_u32 s46, s46, s36
    s_and_b32 s47, s45, 1
    s_lshl1_add_u32 s46, s46, s47
    s_mulk_i32 s46, 3072
    s_lshr_b32 s47, s45, 2
    s_mul_i32 s47, s47, 6291456
    s_add_u32 s46, s46, s47
    buffer_load_dwordx4 v[64:67], v1, s[16:19], s46 offen offset:0
    buffer_load_dwordx4 v[68:71], v1, s[16:19], s46 offen offset:128
    buffer_load_dwordx4 v[72:75], v1, s[16:19], s46 offen offset:256
    s_waitcnt vmcnt(0)
    v_lshlrev_b32 v40, 16, v64
    v_and_b32 v41, s39, v64
    v_lshlrev_b32 v42, 16, v65
    v_and_b32 v43, s39, v65
    v_lshlrev_b32 v44, 16, v66
    v_and_b32 v45, s39, v66
    v_lshlrev_b32 v46, 16, v67
    v_and_b32 v47, s39, v67
    v_pk_mul_f32 v[40:41], v[40:41], v[16:17]
    v_pk_mul_f32 v[42:43], v[42:43], v[18:19]
    v_pk_mul_f32 v[44:45], v[44:45], v[20:21]
    v_pk_mul_f32 v[46:47], v[46:47], v[22:23]
    v_cvt_pk_bf16_f32 v64, v40, v41
    v_cvt_pk_bf16_f32 v65, v42, v43
    v_cvt_pk_bf16_f32 v66, v44, v45
    v_cvt_pk_bf16_f32 v67, v46, v47
    buffer_store_dwordx4 v[64:67], v1, s[20:23], s46 offen offset:0 sc1
    v_lshlrev_b32 v40, 16, v68
    v_and_b32 v41, s39, v68
    v_lshlrev_b32 v42, 16, v69
    v_and_b32 v43, s39, v69
    v_lshlrev_b32 v44, 16, v70
    v_and_b32 v45, s39, v70
    v_lshlrev_b32 v46, 16, v71
    v_and_b32 v47, s39, v71
    v_pk_mul_f32 v[40:41], v[40:41], v[24:25]
    v_pk_mul_f32 v[42:43], v[42:43], v[26:27]
    v_pk_mul_f32 v[44:45], v[44:45], v[28:29]
    v_pk_mul_f32 v[46:47], v[46:47], v[30:31]
    v_cvt_pk_bf16_f32 v68, v40, v41
    v_cvt_pk_bf16_f32 v69, v42, v43
    v_cvt_pk_bf16_f32 v70, v44, v45
    v_cvt_pk_bf16_f32 v71, v46, v47
    buffer_store_dwordx4 v[68:71], v1, s[20:23], s46 offen offset:128 sc1
    v_lshlrev_b32 v40, 16, v72
    v_and_b32 v41, s39, v72
    v_lshlrev_b32 v42, 16, v73
    v_and_b32 v43, s39, v73
    v_lshlrev_b32 v44, 16, v74
    v_and_b32 v45, s39, v74
    v_lshlrev_b32 v46, 16, v75
    v_and_b32 v47, s39, v75
    v_pk_mul_f32 v[40:41], v[40:41], v[32:33]
    v_pk_mul_f32 v[42:43], v[42:43], v[34:35]
    v_pk_mul_f32 v[44:45], v[44:45], v[36:37]
    v_pk_mul_f32 v[46:47], v[46:47], v[38:39]
    v_cvt_pk_bf16_f32 v72, v40, v41
    v_cvt_pk_bf16_f32 v73, v42, v43
    v_cvt_pk_bf16_f32 v74, v44, v45
    v_cvt_pk_bf16_f32 v75, v46, v47
    buffer_store_dwordx4 v[72:75], v1, s[20:23], s46 offen offset:256 sc1
    s_waitcnt vmcnt(0)
    s_add_u32 s45, s45, 1
    s_cmp_lt_u32 s45, 64
    s_cbranch_scc1 L_solo_out
    s_endpgm
L_codeend:
.section .rodata,"a"
.p2align 6
.amdhsa_kernel standalone__se_block__vision_kernel
  .amdhsa_next_free_vgpr 256
  .amdhsa_next_free_sgpr 102
  .amdhsa_accum_offset 256
  .amdhsa_group_segment_fixed_size 0
  .amdhsa_kernarg_size 48
  .amdhsa_user_sgpr_count 2
  .amdhsa_user_sgpr_kernarg_segment_ptr 1
  .amdhsa_system_sgpr_workgroup_id_x 1
  .amdhsa_float_denorm_mode_32 3
.end_amdhsa_kernel
```
